```python
import torch

def _softmax(x, axis=-1):
    return torch.softmax(x, dim=axis)
def _gelu(x):
    return torch.nn.functional.gelu(x, approximate="tanh")
def _silu(x):
    return torch.nn.functional.silu(x)
def _sigmoid(x):
    return torch.sigmoid(x)
def _layernorm(x, axis=-1, eps=1e-5):
    m = x.mean(dim=axis, keepdim=True)
    v = x.var(dim=axis, keepdim=True, unbiased=False)
    return (x - m) / torch.sqrt(v + eps)
def _scatter_add(tgt, idx, src, axis=0):
    return tgt.clone().index_add_(axis, idx, src)
def _segment_sum(src, seg, n):
    out = torch.zeros((n,) + src.shape[1:], dtype=src.dtype)
    return out.index_add_(0, seg, src)
def _pad(x, pw):
    flat = tuple(v for pair in reversed(pw) for v in pair)
    return torch.nn.functional.pad(x, flat)

kernel_name = 'recurrent_scan__sliding_block_cached__glu_gated_geglu__decode'

def setup_inputs():

    _w = (lambda a: (lambda t: t.to(torch.bfloat16) if t.is_floating_point() else t)(torch.as_tensor(a)))
    def _A_setup():
        B, Sq, D = 4, 1, 576
        Hq, Hkv, Sk, Dh = 32, 16, 4096, 128
        assert Hq % Hkv == 0, (Hq, Hkv)
        return {
            "x": _w((lambda *s: torch.randn(*s, dtype=torch.bfloat16) * 0.2)(B, Sq, D)),
            "k_cache": _w((lambda *s: torch.randn(*s, dtype=torch.bfloat16) * 1.6)(B, Hkv, Sk, Dh)),
            "v_cache": _w((lambda *s: torch.randn(*s, dtype=torch.bfloat16) * 1.6)(B, Hkv, Sk, Dh)),
            "wq": _w((lambda *s: torch.randn(*s, dtype=torch.bfloat16) * 1.6)(D, Hq * Dh) * (D ** -0.5)),
            "wo": _w((lambda *s: torch.randn(*s, dtype=torch.bfloat16) * 1.6)(Hq * Dh, D) * ((Hq * Dh) ** -0.5)),
        }
    _A_in = _A_setup()

    def _B_setup():
        B, S, Dm, Df = 4, 1, 576, 4608
        return {
            "x": _w((lambda *s: torch.randn(*s, dtype=torch.bfloat16) * 0.2)(B, S, Dm)),
            "w_gate": _w((lambda *s: torch.randn(*s, dtype=torch.bfloat16) * 0.8)(Dm, Df) * (Dm ** -0.5)),
            "w_up": _w((lambda *s: torch.randn(*s, dtype=torch.bfloat16) * 0.8)(Dm, Df) * (Dm ** -0.5)),
            "w_down": _w((lambda *s: torch.randn(*s, dtype=torch.bfloat16) * 0.8)(Df, Dm) * (Df ** -0.5)),
        }
    _B_in = _B_setup()

    return {
        "A_x": _A_in["x"],
        "A_k_cache": _A_in["k_cache"],
        "A_v_cache": _A_in["v_cache"],
        "A_wq": _A_in["wq"],
        "A_wo": _A_in["wo"],
        "B_x": _B_in["x"],
        "B_w_gate": _B_in["w_gate"],
        "B_w_up": _B_in["w_up"],
        "B_w_down": _B_in["w_down"],
    }

def reference(A_x, A_k_cache, A_v_cache, A_wq, A_wo, B_x, B_w_gate, B_w_up, B_w_down):
    def _A_ref(x, k_cache, v_cache, wq, wo):
        B, Sq, D = x.shape
        Hq, Dh = 32, 128
        Hkv, Sk = k_cache.shape[1], k_cache.shape[2]
        W = min(4096, max(256, Sk // 4))
        rep = Hq // Hkv
        q = (lambda x, *d: x.permute(*d))((x @ wq).reshape(B, Sq, Hq, Dh), 0, 2, 1, 3)
        k = (lambda x, n, axis: torch.repeat_interleave(x, n, dim=axis))(k_cache[:, :, Sk - W:, :], rep, axis=1)
        v = (lambda x, n, axis: torch.repeat_interleave(x, n, dim=axis))(v_cache[:, :, Sk - W:, :], rep, axis=1)
        scores = torch.einsum("bhqd,bhkd->bhqk", q, k) * (Dh ** -0.5)
        p = _softmax(scores, axis=-1)
        o = torch.einsum("bhqk,bhkd->bhqd", p, v)
        return (lambda x, *d: x.permute(*d))(o, 0, 2, 1, 3).reshape(B, Sq, Hq * Dh) @ wo

    def _B_ref(x, w_gate, w_up, w_down):
        g = torch.einsum("bsd,df->bsf", x, w_gate)
        u = torch.einsum("bsd,df->bsf", x, w_up)
        h = _gelu(g) * u
        return torch.einsum("bsf,fd->bsd", h, w_down)

    x = A_x
    xn = _layernorm(x, axis=-1)
    s = _A_ref(xn, A_k_cache, A_v_cache, A_wq, A_wo)
    g = _silu(_B_ref(xn, B_w_gate, B_w_up, B_w_down))
    return x + s * g
```

```asm
; @launch grid=(256,1,1) block=(640,1,1) lds=147456
.amdgcn_target "amdgcn-amd-amdhsa--gfx950"
.text
.globl recurrent_scan__sliding_block_cached__glu_gated_geglu__decode_kernel
.p2align 8
.type recurrent_scan__sliding_block_cached__glu_gated_geglu__decode_kernel,@function
recurrent_scan__sliding_block_cached__glu_gated_geglu__decode_kernel:
    s_load_dwordx2 s[24:25], s[0:1], 0
    s_getpc_b64 s[92:93]
L_epf:
    v_mul_u32_u24 v156, 20, v0
    global_load_dword v156, v156, s[92:93] offset:252
    v_cmp_gt_u32 vcc, 64, v0
    s_cbranch_vccz L_comp
    s_lshr_b32 s34, s2, 3
    s_add_u32 s56, s34, 1
    s_mul_i32 s56, s56, 57
    s_lshr_b32 s45, s56, 9
    s_cselect_b32 s56, 40, 24
    s_cselect_b32 s50, 9, 8
    s_lshl3_add_u32 s56, s45, s56
    s_load_dwordx2 s[4:5], s[0:1], s56
    s_and_b32 s33, s2, 7
    s_sub_u32 s57, s33, s45
    s_add_u32 s57, s57, 1
    s_mul_i32 s57, s57, s50
    s_add_u32 s49, s57, s34
    s_mul_i32 s40, s2, 13
    s_and_b32 s40, s40, 63
    s_mul_i32 s40, s40, 14
    s_lshr_b32 s40, s40, 6
    s_setprio 3
    s_lshl_b32 s44, s50, 9
    s_mul_i32 s56, s40, s44
    s_lshl1_add_u32 s43, s49, s56
    s_lshl_b32 s43, s43, 6
    s_addk_i32 s43, -1024
    s_cmp_lt_u32 s34, 26
    s_cbranch_scc1 L_lgo
    s_cmp_ge_u32 s34, 32
    s_cbranch_scc1 L_end
    s_and_b32 s56, s34, 1
    s_lshl1_add_u32 s56, s33, s56
    s_mulk_i32 s56, 864
    s_lshr_b32 s43, s34, 1
    s_add_u32 s43, s43, s56
    s_mulk_i32 s43, 384
    s_addk_i32 s43, -4864
    s_movk_i32 s44, 576
L_lgo:
    v_lshrrev_b32 v7, 3, v0
    v_bfi_b32 v7, 1, v0, v7
    v_lshlrev_b32 v7, 4, v7
    v_and_b32 v6, 14, v0
    v_mad_u32_u24 v1, v6, s44, v7
    s_mul_i32 s6, s50, 589824
    s_mov_b32 s7, 0x20000
    s_movk_i32 m0, 8192
    s_lshl_b32 s46, s44, 4
    s_waitcnt lgkmcnt(0)
L_lp0:
    buffer_load_dwordx4 v1, s[4:7], s43 offen nt lds
    s_addk_i32 m0, 1024
    s_add_u32 s43, s43, s46
    s_cmpk_lg_u32 m0, 28672
    s_cbranch_scc1 L_lp0
L_first:
    s_load_dwordx4 s[8:11], s[0:1], 8
    s_mov_b32 s3, 0
    s_add_u32 s47, s46, 3072
    s_addk_i32 s46, -1024
    s_cmp_ge_u32 s43, s6
    s_cselect_b32 s41, s6, 0
    s_sub_u32 s43, s43, s41
    s_cmp_lt_u32 s34, 26
    s_cselect_b32 s57, 32, 64
    s_cselect_b32 s18, 8, 9
    s_load_dwordx2 s[16:17], s[0:1], s57
    v_mov_b32 v3, 0
    s_mov_b32 s48, 13
    v_mov_b32 v5, 0
    s_add_u32 s50, s43, s4
    s_bfe_u32 s50, s50, 0x30007
    s_cmp_ge_u32 s34, 26
    s_barrier
    s_cbranch_scc1 L_bodyL
    s_cmp_eq_u32 s50, 3
    s_cbranch_scc1 L_bodyB
L_bodyN:
L_lpSN:
    s_waitcnt vmcnt(19)
    buffer_load_dwordx4 v1, s[4:7], s43 offen offset:0 nt lds
    s_add_u32 s43, s43, s46
    s_waitcnt vmcnt(19)
    buffer_load_dwordx4 v1, s[4:7], s43 offen offset:1024 nt lds
    s_add_u32 s43, s43, s46
    s_waitcnt vmcnt(19)
    buffer_load_dwordx4 v1, s[4:7], s43 offen offset:2048 nt lds
    s_add_u32 s43, s43, s46
    v_add_u32 v5, 1, v5
    s_waitcnt vmcnt(19)
    ds_write_b32 v3, v5 offset:360
    buffer_load_dwordx4 v1, s[4:7], s43 offen offset:3072 nt lds
    s_add_u32 s43, s43, s47
    s_cmp_ge_u32 s43, s6
    s_cselect_b32 s41, s6, 0
    s_sub_u32 s43, s43, s41
L_lbSN:
    s_add_u32 m0, m0, 4096
    s_sub_u32 s48, s48, 1
    s_cmp_lg_u32 s48, 0
    s_cbranch_scc1 L_lpSN
    s_lshl_b32 s53, s33, 5
    s_add_u32 s53, s53, s34
    s_lshr_b32 s56, s53, 4
    s_bfe_u32 s57, s34, 0x20002
    s_mov_b32 s42, s56
    s_lshl_b32 s58, s57, 4
    s_add_u32 s58, s58, s42
    s_lshl_b32 s42, s58, 4
    s_and_b32 s58, s34, 3
    s_add_u32 s42, s42, s58
    s_add_u32 s42, s42, 12
    s_lshl_b32 s42, s42, 16
    s_mov_b32 s51, s42
    s_mul_i32 s56, s2, 40503
    s_bfe_u32 s56, s56, 0x40007
    s_lshl_b32 s56, s56, 12
    s_or_b32 s42, s42, s56
    s_sub_u32 s49, s42, 896
    v_lshl_add_u32 v4, v6, 7, v7
    s_mov_b32 s14, 67108864
    s_mov_b32 s15, 0x20000
    v_lshlrev_b32 v12, 2, v0
    v_min_u32 v12, 28, v12
    s_mov_b32 s54, 6400000
    s_waitcnt lgkmcnt(0)
    s_mov_b64 s[12:13], s[10:11]
    s_mov_b32 s10, 67108864
    s_mov_b32 s11, 0x20000
    s_mov_b32 m0, 81920
    s_mov_b32 s48, 16
    v_subrev_u32 v5, 1, v5
L_lpKN:
    s_waitcnt vmcnt(23)
    buffer_load_dwordx4 v4, s[8:11], s42 offen offset:0 nt lds
    s_waitcnt vmcnt(23)
    buffer_load_dwordx4 v4, s[8:11], s49 offen offset:1024 nt lds
    s_waitcnt vmcnt(23)
    buffer_load_dwordx4 v4, s[8:11], s42 offen offset:2048 nt lds
    v_add_u32 v5, 1, v5
    s_waitcnt vmcnt(23)
    ds_write_b32 v3, v5 offset:360
    buffer_load_dwordx4 v4, s[8:11], s49 offen offset:3072 nt lds
    s_add_u32 s42, s42, 4096
    s_and_b32 s42, s42, 0xffff
    s_or_b32 s42, s42, s51
    s_sub_u32 s49, s42, 896
L_lbKN:
    s_add_u32 m0, m0, 4096
    s_sub_u32 s48, s48, 1
    s_cmp_lg_u32 s48, 0
    s_cbranch_scc1 L_lpKN
    v_mul_u32_u24 v2, 576, v6
    v_add_u32 v2, v2, v7
    s_mul_i32 s18, s18, 589824
    s_mov_b32 s19, 0x20000
    s_sub_u32 s56, 3, s33
    s_and_b32 s56, s56, 7
    s_add_u32 s56, s56, 8
    s_add_u32 s57, s56, 9
    s_mov_b32 s30, s34
    s_cmp_eq_u32 s34, 0
    s_cselect_b32 s30, s56, s30
    s_cmp_eq_u32 s34, s56
    s_cselect_b32 s30, 0, s30
    s_cmp_eq_u32 s34, 1
    s_cselect_b32 s30, s57, s30
    s_cmp_eq_u32 s34, s57
    s_cselect_b32 s30, 1, s30
    s_cmp_eq_u32 s34, 2
    s_cselect_b32 s30, 16, s30
    s_cmp_eq_u32 s34, 16
    s_cselect_b32 s30, 2, s30
    s_cmp_eq_u32 s34, 4
    s_cselect_b32 s30, 25, s30
    s_cmp_eq_u32 s34, 25
    s_cselect_b32 s30, 4, s30
    s_cmp_lt_u32 s30, 8
    s_cselect_b32 s52, 3, 1
    s_cselect_b32 s56, 8, s30
    s_cmp_ge_u32 s56, 17
    s_cselect_b32 s57, 17, 8
    s_cselect_b32 s58, 1, 0
    s_sub_u32 s56, s56, s57
    s_lshl_b32 s57, s33, 1
    s_add_u32 s58, s58, s57
    s_mov_b32 s59, s58
    s_lshl_b32 s59, s59, 3
L_tdonelN:
    s_mul_i32 s45, s59, 36864
    s_lshl_b32 s57, s56, 7
    s_add_u32 s45, s45, s57
L_w_1:
    ds_read_b32 v10, v12 offset:320
    ds_read_b32 v11, v3 offset:372
    s_sub_u32 s54, s54, 1
    s_cbranch_scc1 L_end
    s_waitcnt lgkmcnt(0)
    v_cmp_gt_i32 vcc, 3, v10
    s_cbranch_vccnz L_w_1
    s_mov_b32 m0, 8192
    s_mov_b32 s48, 16
    v_cmp_eq_u32 vcc, 0, v11
    s_cbranch_vccnz L_nb1
    v_subrev_u32 v5, 2, v5
    s_branch L_lpVB
L_nb1:
    s_mov_b32 s48, 4
L_lpVN0:
    s_waitcnt vmcnt(21)
    buffer_load_dwordx4 v4, s[12:15], s42 offen offset:0 nt lds
    v_add_u32 v5, 1, v5
    s_waitcnt vmcnt(21)
    ds_write_b32 v3, v5 offset:360
    buffer_load_dwordx4 v4, s[12:15], s49 offen offset:1024 nt lds
    s_waitcnt vmcnt(21)
    buffer_load_dwordx4 v4, s[12:15], s42 offen offset:2048 nt lds
    s_waitcnt vmcnt(21)
    buffer_load_dwordx4 v4, s[12:15], s49 offen offset:3072 nt lds
    s_add_u32 s42, s42, 4096
    s_and_b32 s42, s42, 0xffff
    s_or_b32 s42, s42, s51
    s_sub_u32 s49, s42, 896
L_lbVN0:
    s_add_u32 m0, m0, 4096
    s_sub_u32 s48, s48, 1
    s_cmp_lg_u32 s48, 0
    s_cbranch_scc1 L_lpVN0
    ds_read_b32 v11, v3 offset:372
    s_mov_b32 s48, 12
    s_waitcnt lgkmcnt(0)
    v_cmp_eq_u32 vcc, 0, v11
    s_cbranch_vccnz L_lpVN
    v_subrev_u32 v5, 2, v5
    s_branch L_lpVB
L_lpVN:
    s_waitcnt vmcnt(21)
    buffer_load_dwordx4 v4, s[12:15], s42 offen offset:0 nt lds
    v_add_u32 v5, 1, v5
    s_waitcnt vmcnt(21)
    ds_write_b32 v3, v5 offset:360
    buffer_load_dwordx4 v4, s[12:15], s49 offen offset:1024 nt lds
    s_waitcnt vmcnt(21)
    buffer_load_dwordx4 v4, s[12:15], s42 offen offset:2048 nt lds
    s_waitcnt vmcnt(21)
    buffer_load_dwordx4 v4, s[12:15], s49 offen offset:3072 nt lds
    s_add_u32 s42, s42, 4096
    s_and_b32 s42, s42, 0xffff
    s_or_b32 s42, s42, s51
    s_sub_u32 s49, s42, 896
L_lbVN:
    s_add_u32 m0, m0, 4096
    s_sub_u32 s48, s48, 1
    s_cmp_lg_u32 s48, 0
    s_cbranch_scc1 L_lpVN
    s_cmp_eq_u32 s52, 1
    s_cbranch_scc0 L_tdN
L_w_2:
    ds_read_b32 v10, v12 offset:320
    s_sub_u32 s54, s54, 1
    s_cbranch_scc1 L_end
    s_waitcnt lgkmcnt(0)
    v_cmp_gt_i32 vcc, 4, v10
    s_cbranch_vccnz L_w_2
    s_mov_b32 m0, 73728
    s_mov_b32 s48, 8
L_lpTN:
    s_waitcnt vmcnt(23)
    buffer_load_dwordx4 v2, s[16:19], s45 offen offset:0 nt lds
    s_add_u32 s45, s45, 8192
    s_waitcnt vmcnt(23)
    buffer_load_dwordx4 v2, s[16:19], s45 offen offset:1024 nt lds
    s_add_u32 s45, s45, 137216
    s_waitcnt vmcnt(23)
    buffer_load_dwordx4 v2, s[16:19], s45 offen offset:2048 nt lds
    s_add_u32 s45, s45, 8192
    v_add_u32 v5, 1, v5
    s_waitcnt vmcnt(23)
    ds_write_b32 v3, v5 offset:360
    buffer_load_dwordx4 v2, s[16:19], s45 offen offset:3072 nt lds
    s_add_u32 s45, s45, 4294832128
L_lbTN:
    s_add_u32 m0, m0, 4096
    s_sub_u32 s48, s48, 1
    s_cmp_lg_u32 s48, 0
    s_cbranch_scc1 L_lpTN
    v_add_u32 v5, 1, v5
    s_waitcnt vmcnt(20)
    ds_write_b32 v3, v5 offset:360
    v_add_u32 v5, 1, v5
    s_waitcnt vmcnt(16)
    ds_write_b32 v3, v5 offset:360
    v_add_u32 v5, 1, v5
    s_waitcnt vmcnt(12)
    ds_write_b32 v3, v5 offset:360
    v_add_u32 v5, 1, v5
    s_waitcnt vmcnt(8)
    ds_write_b32 v3, v5 offset:360
    v_add_u32 v5, 1, v5
    s_waitcnt vmcnt(4)
    ds_write_b32 v3, v5 offset:360
    v_add_u32 v5, 1, v5
    s_waitcnt vmcnt(0)
    ds_write_b32 v3, v5 offset:360
    s_endpgm
L_tdN:
    v_add_u32 v5, 1, v5
    s_waitcnt vmcnt(20)
    ds_write_b32 v3, v5 offset:360
    v_add_u32 v5, 1, v5
    s_waitcnt vmcnt(16)
    ds_write_b32 v3, v5 offset:360
    v_add_u32 v5, 1, v5
    s_waitcnt vmcnt(12)
    ds_write_b32 v3, v5 offset:360
    v_add_u32 v5, 1, v5
    s_waitcnt vmcnt(8)
    ds_write_b32 v3, v5 offset:360
    v_add_u32 v5, 1, v5
    s_waitcnt vmcnt(4)
    ds_write_b32 v3, v5 offset:360
    v_add_u32 v5, 1, v5
    s_waitcnt vmcnt(0)
    ds_write_b32 v3, v5 offset:360
    s_endpgm
L_bodyB:
    v_subrev_u32 v5, 3, v5
L_lpSB:
    s_waitcnt vmcnt(31)
    buffer_load_dwordx4 v1, s[4:7], s43 offen offset:0 nt lds
    s_add_u32 s43, s43, s46
    s_waitcnt vmcnt(31)
    buffer_load_dwordx4 v1, s[4:7], s43 offen offset:1024 nt lds
    s_add_u32 s43, s43, s46
    s_waitcnt vmcnt(31)
    buffer_load_dwordx4 v1, s[4:7], s43 offen offset:2048 nt lds
    s_add_u32 s43, s43, s46
    v_add_u32 v5, 1, v5
    s_waitcnt vmcnt(31)
    ds_write_b32 v3, v5 offset:360
    buffer_load_dwordx4 v1, s[4:7], s43 offen offset:3072 nt lds
    s_add_u32 s43, s43, s47
    s_cmp_ge_u32 s43, s6
    s_cselect_b32 s41, s6, 0
    s_sub_u32 s43, s43, s41
L_lbSB:
    s_add_u32 m0, m0, 4096
    s_sub_u32 s48, s48, 1
    s_cmp_lg_u32 s48, 0
    s_cbranch_scc1 L_lpSB
    s_lshl_b32 s53, s33, 5
    s_add_u32 s53, s53, s34
    s_lshr_b32 s56, s53, 4
    s_bfe_u32 s57, s34, 0x20002
    s_mov_b32 s42, s56
    s_lshl_b32 s58, s57, 4
    s_add_u32 s58, s58, s42
    s_lshl_b32 s42, s58, 4
    s_and_b32 s58, s34, 3
    s_add_u32 s42, s42, s58
    s_add_u32 s42, s42, 12
    s_lshl_b32 s42, s42, 16
    s_mov_b32 s51, s42
    s_mul_i32 s56, s2, 40503
    s_bfe_u32 s56, s56, 0x40007
    s_lshl_b32 s56, s56, 12
    s_or_b32 s42, s42, s56
    s_sub_u32 s49, s42, 896
    v_lshl_add_u32 v4, v6, 7, v7
    s_mov_b32 s14, 67108864
    s_mov_b32 s15, 0x20000
    v_lshlrev_b32 v12, 2, v0
    v_min_u32 v12, 28, v12
    s_mov_b32 s54, 6400000
    s_waitcnt lgkmcnt(0)
    s_mov_b64 s[12:13], s[10:11]
    s_mov_b32 s10, 67108864
    s_mov_b32 s11, 0x20000
    s_mov_b32 m0, 81920
    s_mov_b32 s48, 16
L_lpKB:
    s_waitcnt vmcnt(29)
    buffer_load_dwordx4 v4, s[8:11], s42 offen offset:0 nt lds
    v_add_u32 v5, 1, v5
    s_waitcnt vmcnt(29)
    ds_write_b32 v3, v5 offset:360
    buffer_load_dwordx4 v4, s[8:11], s49 offen offset:1024 nt lds
    s_waitcnt vmcnt(29)
    buffer_load_dwordx4 v4, s[8:11], s42 offen offset:2048 nt lds
    s_waitcnt vmcnt(29)
    buffer_load_dwordx4 v4, s[8:11], s49 offen offset:3072 nt lds
    s_add_u32 s42, s42, 4096
    s_and_b32 s42, s42, 0xffff
    s_or_b32 s42, s42, s51
    s_sub_u32 s49, s42, 896
L_lbKB:
    s_add_u32 m0, m0, 4096
    s_sub_u32 s48, s48, 1
    s_cmp_lg_u32 s48, 0
    s_cbranch_scc1 L_lpKB
    v_mul_u32_u24 v2, 576, v6
    v_add_u32 v2, v2, v7
    s_mul_i32 s18, s18, 589824
    s_mov_b32 s19, 0x20000
    s_sub_u32 s56, 3, s33
    s_and_b32 s56, s56, 7
    s_add_u32 s56, s56, 8
    s_add_u32 s57, s56, 9
    s_mov_b32 s30, s34
    s_cmp_eq_u32 s34, 0
    s_cselect_b32 s30, s56, s30
    s_cmp_eq_u32 s34, s56
    s_cselect_b32 s30, 0, s30
    s_cmp_eq_u32 s34, 1
    s_cselect_b32 s30, s57, s30
    s_cmp_eq_u32 s34, s57
    s_cselect_b32 s30, 1, s30
    s_cmp_eq_u32 s34, 2
    s_cselect_b32 s30, 16, s30
    s_cmp_eq_u32 s34, 16
    s_cselect_b32 s30, 2, s30
    s_cmp_eq_u32 s34, 4
    s_cselect_b32 s30, 25, s30
    s_cmp_eq_u32 s34, 25
    s_cselect_b32 s30, 4, s30
    s_cmp_lt_u32 s30, 8
    s_cselect_b32 s52, 3, 1
    s_cselect_b32 s56, 8, s30
    s_cmp_ge_u32 s56, 17
    s_cselect_b32 s57, 17, 8
    s_cselect_b32 s58, 1, 0
    s_sub_u32 s56, s56, s57
    s_lshl_b32 s57, s33, 1
    s_add_u32 s58, s58, s57
    s_mov_b32 s59, s58
    s_lshl_b32 s59, s59, 3
L_tdonelB:
    s_mul_i32 s45, s59, 36864
    s_lshl_b32 s57, s56, 7
    s_add_u32 s45, s45, s57
L_w_3:
    ds_read_b32 v10, v12 offset:320
    s_sub_u32 s54, s54, 1
    s_cbranch_scc1 L_end
    s_waitcnt lgkmcnt(0)
    v_cmp_gt_i32 vcc, 3, v10
    s_cbranch_vccnz L_w_3
    s_mov_b32 m0, 8192
    s_mov_b32 s48, 16
L_lpVB:
    s_waitcnt vmcnt(30)
    buffer_load_dwordx4 v4, s[12:15], s42 offen offset:0 nt lds
    s_waitcnt vmcnt(30)
    buffer_load_dwordx4 v4, s[12:15], s49 offen offset:1024 nt lds
    v_add_u32 v5, 1, v5
    s_waitcnt vmcnt(30)
    ds_write_b32 v3, v5 offset:360
    buffer_load_dwordx4 v4, s[12:15], s42 offen offset:2048 nt lds
    s_waitcnt vmcnt(30)
    buffer_load_dwordx4 v4, s[12:15], s49 offen offset:3072 nt lds
    s_add_u32 s42, s42, 4096
    s_and_b32 s42, s42, 0xffff
    s_or_b32 s42, s42, s51
    s_sub_u32 s49, s42, 896
L_lbVB:
    s_add_u32 m0, m0, 4096
    s_sub_u32 s48, s48, 1
    s_cmp_lg_u32 s48, 0
    s_cbranch_scc1 L_lpVB
    s_cmp_eq_u32 s52, 1
    s_cbranch_scc0 L_tdB
L_w_4:
    ds_read_b32 v10, v12 offset:320
    s_sub_u32 s54, s54, 1
    s_cbranch_scc1 L_end
    s_waitcnt lgkmcnt(0)
    v_cmp_gt_i32 vcc, 4, v10
    s_cbranch_vccnz L_w_4
    s_mov_b32 m0, 73728
    s_mov_b32 s48, 8
L_lpTB:
    s_waitcnt vmcnt(31)
    buffer_load_dwordx4 v2, s[16:19], s45 offen offset:0 nt lds
    s_add_u32 s45, s45, 8192
    s_waitcnt vmcnt(31)
    buffer_load_dwordx4 v2, s[16:19], s45 offen offset:1024 nt lds
    s_add_u32 s45, s45, 137216
    s_waitcnt vmcnt(31)
    buffer_load_dwordx4 v2, s[16:19], s45 offen offset:2048 nt lds
    s_add_u32 s45, s45, 8192
    v_add_u32 v5, 1, v5
    s_waitcnt vmcnt(31)
    ds_write_b32 v3, v5 offset:360
    buffer_load_dwordx4 v2, s[16:19], s45 offen offset:3072 nt lds
    s_add_u32 s45, s45, 4294832128
L_lbTB:
    s_add_u32 m0, m0, 4096
    s_sub_u32 s48, s48, 1
    s_cmp_lg_u32 s48, 0
    s_cbranch_scc1 L_lpTB
    v_add_u32 v5, 1, v5
    s_waitcnt vmcnt(28)
    ds_write_b32 v3, v5 offset:360
    v_add_u32 v5, 1, v5
    s_waitcnt vmcnt(24)
    ds_write_b32 v3, v5 offset:360
    v_add_u32 v5, 1, v5
    s_waitcnt vmcnt(20)
    ds_write_b32 v3, v5 offset:360
    v_add_u32 v5, 1, v5
    s_waitcnt vmcnt(16)
    ds_write_b32 v3, v5 offset:360
    v_add_u32 v5, 1, v5
    s_waitcnt vmcnt(12)
    ds_write_b32 v3, v5 offset:360
    v_add_u32 v5, 1, v5
    s_waitcnt vmcnt(8)
    ds_write_b32 v3, v5 offset:360
    v_add_u32 v5, 1, v5
    s_waitcnt vmcnt(4)
    ds_write_b32 v3, v5 offset:360
    v_add_u32 v5, 1, v5
    s_waitcnt vmcnt(0)
    ds_write_b32 v3, v5 offset:360
    s_endpgm
L_tdB:
    v_add_u32 v5, 1, v5
    s_waitcnt vmcnt(28)
    ds_write_b32 v3, v5 offset:360
    v_add_u32 v5, 1, v5
    s_waitcnt vmcnt(24)
    ds_write_b32 v3, v5 offset:360
    v_add_u32 v5, 1, v5
    s_waitcnt vmcnt(20)
    ds_write_b32 v3, v5 offset:360
    v_add_u32 v5, 1, v5
    s_waitcnt vmcnt(16)
    ds_write_b32 v3, v5 offset:360
    v_add_u32 v5, 1, v5
    s_waitcnt vmcnt(12)
    ds_write_b32 v3, v5 offset:360
    v_add_u32 v5, 1, v5
    s_waitcnt vmcnt(8)
    ds_write_b32 v3, v5 offset:360
    v_add_u32 v5, 1, v5
    s_waitcnt vmcnt(4)
    ds_write_b32 v3, v5 offset:360
    v_add_u32 v5, 1, v5
    s_waitcnt vmcnt(0)
    ds_write_b32 v3, v5 offset:360
    s_endpgm
L_bodyL:
    v_mov_b32 v5, 9
    s_mov_b32 s48, 4
    v_subrev_u32 v5, 2, v5
L_lpSL:
    s_waitcnt vmcnt(25)
    buffer_load_dwordx4 v1, s[4:7], s43 offen offset:0 nt lds
    s_add_u32 s43, s43, s46
    v_add_u32 v5, 1, v5
    s_waitcnt vmcnt(25)
    ds_write_b32 v3, v5 offset:360
    buffer_load_dwordx4 v1, s[4:7], s43 offen offset:1024 nt lds
    s_add_u32 s43, s43, s46
    s_waitcnt vmcnt(25)
    buffer_load_dwordx4 v1, s[4:7], s43 offen offset:2048 nt lds
    s_add_u32 s43, s43, s46
    s_waitcnt vmcnt(25)
    buffer_load_dwordx4 v1, s[4:7], s43 offen offset:3072 nt lds
    s_add_u32 s43, s43, s47
    s_cmp_ge_u32 s43, s6
    s_cselect_b32 s41, s6, 0
    s_sub_u32 s43, s43, s41
L_lbSL:
    s_add_u32 m0, m0, 4096
    s_sub_u32 s48, s48, 1
    s_cmp_lg_u32 s48, 0
    s_cbranch_scc1 L_lpSL
    s_lshl_b32 s53, s33, 5
    s_add_u32 s53, s53, s34
    s_lshr_b32 s56, s53, 4
    s_bfe_u32 s57, s34, 0x20002
    s_mov_b32 s42, s56
    s_lshl_b32 s58, s57, 4
    s_add_u32 s58, s58, s42
    s_lshl_b32 s42, s58, 4
    s_and_b32 s58, s34, 3
    s_add_u32 s42, s42, s58
    s_add_u32 s42, s42, 12
    s_lshl_b32 s42, s42, 16
    s_mov_b32 s51, s42
    s_mul_i32 s56, s2, 40503
    s_bfe_u32 s56, s56, 0x40007
    s_lshl_b32 s56, s56, 12
    s_or_b32 s42, s42, s56
    s_sub_u32 s49, s42, 896
    v_lshl_add_u32 v4, v6, 7, v7
    s_mov_b32 s14, 67108864
    s_mov_b32 s15, 0x20000
    v_lshlrev_b32 v12, 2, v0
    v_min_u32 v12, 28, v12
    s_mov_b32 s54, 6400000
    s_waitcnt lgkmcnt(0)
    s_mov_b64 s[12:13], s[10:11]
    s_mov_b32 s10, 67108864
    s_mov_b32 s11, 0x20000
    s_mov_b32 m0, 81920
    s_mov_b32 s48, 16
L_lpKL:
    s_waitcnt vmcnt(25)
    buffer_load_dwordx4 v4, s[8:11], s42 offen offset:0 nt lds
    v_add_u32 v5, 1, v5
    s_waitcnt vmcnt(25)
    ds_write_b32 v3, v5 offset:360
    buffer_load_dwordx4 v4, s[8:11], s49 offen offset:1024 nt lds
    s_waitcnt vmcnt(25)
    buffer_load_dwordx4 v4, s[8:11], s42 offen offset:2048 nt lds
    s_waitcnt vmcnt(25)
    buffer_load_dwordx4 v4, s[8:11], s49 offen offset:3072 nt lds
    s_add_u32 s42, s42, 4096
    s_and_b32 s42, s42, 0xffff
    s_or_b32 s42, s42, s51
    s_sub_u32 s49, s42, 896
L_lbKL:
    s_add_u32 m0, m0, 4096
    s_sub_u32 s48, s48, 1
    s_cmp_lg_u32 s48, 0
    s_cbranch_scc1 L_lpKL
    v_mul_u32_u24 v2, 576, v6
    v_add_u32 v2, v2, v7
    s_mul_i32 s18, s18, 589824
    s_mov_b32 s19, 0x20000
    s_sub_u32 s56, s34, 26
    s_lshr_b32 s57, s56, 1
    s_mul_i32 s57, s57, 3
    s_and_b32 s56, s56, 1
    s_lshl_b32 s56, s56, 1
    s_add_u32 s56, s56, s57
    s_add_u32 s57, s57, 1
    s_mov_b32 s52, 2
    s_mul_i32 s59, s33, 18
    s_add_u32 s58, s33, 16
L_tdonelL:
    s_mul_i32 s45, s59, 36864
    s_lshl_b32 s57, s56, 7
    s_add_u32 s45, s45, s57
L_w_5:
    ds_read_b32 v10, v12 offset:320
    s_sub_u32 s54, s54, 1
    s_cbranch_scc1 L_end
    s_waitcnt lgkmcnt(0)
    v_cmp_gt_i32 vcc, 3, v10
    s_cbranch_vccnz L_w_5
    s_mov_b32 m0, 8192
    s_mov_b32 s48, 16
L_lpVL:
    v_add_u32 v5, 1, v5
    s_waitcnt vmcnt(24)
    ds_write_b32 v3, v5 offset:360
    buffer_load_dwordx4 v4, s[12:15], s42 offen offset:0 nt lds
    s_waitcnt vmcnt(24)
    buffer_load_dwordx4 v4, s[12:15], s49 offen offset:1024 nt lds
    s_waitcnt vmcnt(24)
    buffer_load_dwordx4 v4, s[12:15], s42 offen offset:2048 nt lds
    s_waitcnt vmcnt(24)
    buffer_load_dwordx4 v4, s[12:15], s49 offen offset:3072 nt lds
    s_add_u32 s42, s42, 4096
    s_and_b32 s42, s42, 0xffff
    s_or_b32 s42, s42, s51
    s_sub_u32 s49, s42, 896
L_lbVL:
    s_add_u32 m0, m0, 4096
    s_sub_u32 s48, s48, 1
    s_cmp_lg_u32 s48, 0
    s_cbranch_scc1 L_lpVL
L_w_6:
    ds_read_b32 v10, v12 offset:320
    s_sub_u32 s54, s54, 1
    s_cbranch_scc1 L_end
    s_waitcnt lgkmcnt(0)
    v_cmp_gt_i32 vcc, 4, v10
    s_cbranch_vccnz L_w_6
    s_mov_b32 m0, 73728
    s_mov_b32 s48, 18
L_lpTL:
    v_add_u32 v5, 1, v5
    s_waitcnt vmcnt(24)
    ds_write_b32 v3, v5 offset:360
    buffer_load_dwordx4 v2, s[16:19], s45 offen offset:0 nt lds
    s_add_u32 s45, s45, 8192
    s_waitcnt vmcnt(24)
    buffer_load_dwordx4 v2, s[16:19], s45 offen offset:1024 nt lds
    s_add_u32 s45, s45, 8192
    s_waitcnt vmcnt(24)
    buffer_load_dwordx4 v2, s[16:19], s45 offen offset:2048 nt lds
    s_add_u32 s45, s45, 8192
    s_waitcnt vmcnt(24)
    buffer_load_dwordx4 v2, s[16:19], s45 offen offset:3072 nt lds
    s_add_u32 s45, s45, 12288
L_lbTL:
    s_add_u32 m0, m0, 4096
    s_sub_u32 s48, s48, 1
    s_cmp_lg_u32 s48, 0
    s_cbranch_scc1 L_lpTL
    v_add_u32 v5, 1, v5
    s_waitcnt vmcnt(24)
    ds_write_b32 v3, v5 offset:360
    v_add_u32 v5, 1, v5
    s_waitcnt vmcnt(20)
    ds_write_b32 v3, v5 offset:360
    v_add_u32 v5, 1, v5
    s_waitcnt vmcnt(16)
    ds_write_b32 v3, v5 offset:360
    v_add_u32 v5, 1, v5
    s_waitcnt vmcnt(12)
    ds_write_b32 v3, v5 offset:360
    v_add_u32 v5, 1, v5
    s_waitcnt vmcnt(8)
    ds_write_b32 v3, v5 offset:360
    v_add_u32 v5, 1, v5
    s_waitcnt vmcnt(4)
    ds_write_b32 v3, v5 offset:360
    v_add_u32 v5, 1, v5
    s_waitcnt vmcnt(0)
    ds_write_b32 v3, v5 offset:360
    s_endpgm
L_comp:
    s_load_dwordx2 s[20:21], s[0:1], 88
    v_readfirstlane_b32 s3, v0
    s_cmp_ge_u32 s2, 256
    s_cbranch_scc1 L_end
    s_lshr_b32 s3, s3, 6
    s_lshr_b32 s34, s2, 3
    s_add_u32 s56, s34, 1
    s_mul_i32 s56, s56, 57
    s_lshr_b32 s45, s56, 9
    s_cselect_b32 s50, 9, 8
    s_and_b32 s33, s2, 7
    s_sub_u32 s57, s33, s45
    s_add_u32 s57, s57, 1
    s_mul_i32 s57, s57, s50
    s_add_u32 s49, s57, s34
    s_mul_i32 s40, s2, 13
    s_and_b32 s40, s40, 63
    s_mul_i32 s40, s40, 14
    s_lshr_b32 s40, s40, 6
    v_and_b32 v0, 63, v0
    s_mov_b32 s23, 0x20000
    s_mov_b32 s22, 268435456
    v_mov_b32 v3, 0
    s_sub_u32 s35, s3, 1
    s_cmp_lg_u32 s35, 8
    s_cbranch_scc1 L_notp0
    s_setprio 2
    v_and_b32 v15, 0x3c, v0
    ds_write_b32 v15, v3 offset:320
L_notp0:
    v_lshrrev_b32 v14, 4, v0
    v_and_b32 v15, 15, v0
    v_mul_u32_u24 v11, 1152, v14
    v_lshl_add_u32 v10, v15, 3, v11
    s_lshl_b32 s57, s35, 7
    s_mul_i32 s59, s45, 72
    s_add_u32 s49, s49, s59
    s_cmp_lt_u32 s34, 8
    s_cselect_b32 s59, 8, 16
    s_sub_u32 s49, s49, s59
    s_cmp_lt_u32 s34, 8
    s_cselect_b32 s59, 8, 10
    s_lshl_b32 s49, s49, s59
    s_add_u32 s49, s49, 65536
    s_cmp_ge_u32 s34, 26
    s_waitcnt lgkmcnt(0)
    s_load_dword s32, s[20:21], 0
    s_load_dwordx2 s[94:95], s[24:25], 0
    s_mov_b32 s26, 4608
    s_mov_b32 s27, 0x20000
    s_cbranch_scc1 L_nox
    buffer_load_dwordx2 v[72:73], v10, s[24:27], s57 offen
    buffer_load_ushort v76, v11, s[24:27], 0 offen
L_nox:
    s_barrier
    s_lshl_b32 s53, s33, 5
    s_add_u32 s53, s53, s34
    s_lshr_b32 s56, s53, 4
    s_bfe_u32 s57, s34, 0x20002
    s_mov_b32 s42, s56
    s_lshl_b32 s58, s57, 4
    s_add_u32 s58, s58, s42
    s_lshl_b32 s42, s58, 4
    s_and_b32 s58, s34, 3
    s_add_u32 s42, s42, s58
    s_add_u32 s42, s42, 12
    s_lshl_b32 s42, s42, 16
    s_lshl3_add_u32 s58, s53, s35
    s_lshl_b32 s58, s58, 7
    s_add_u32 s58, s58, 393216
    s_lshl_b32 s59, s53, 7
    s_add_u32 s59, s59, 327680
    s_cmp_eq_u32 s35, 8
    s_cselect_b32 s58, s59, s58
    s_mov_b64 exec, 1
    buffer_load_dword v157, v3, s[20:23], s58 offen sc1
    s_cbranch_scc1 L_nop4
    s_cmp_ge_u32 s34, 26
    s_cbranch_scc1 L_nop4
    s_cmp_lt_u32 s34, 8
    s_cselect_b32 s59, 14, 8
    s_lshr_b32 s58, s35, 1
    s_lshl_b32 s58, s58, s59
    s_and_b32 s59, s35, 1
    s_lshl_b32 s59, s59, 7
    s_add_u32 s58, s58, s59
    s_add_u32 s58, s58, s49
    buffer_load_dword v158, v3, s[20:23], s58 offen sc1
L_nop4:
    s_mov_b64 exec, -1
    s_lshl_b32 s48, s56, 10
    s_mul_i32 s58, s57, 16384
    s_add_u32 s48, s48, s58
    s_add_u32 s48, s48, 65536
    s_sub_u32 s56, 3, s33
    s_and_b32 s56, s56, 7
    s_add_u32 s56, s56, 8
    s_add_u32 s57, s56, 9
    s_mov_b32 s30, s34
    s_cmp_eq_u32 s34, 0
    s_cselect_b32 s30, s56, s30
    s_cmp_eq_u32 s34, s56
    s_cselect_b32 s30, 0, s30
    s_cmp_eq_u32 s34, 1
    s_cselect_b32 s30, s57, s30
    s_cmp_eq_u32 s34, s57
    s_cselect_b32 s30, 1, s30
    s_cmp_eq_u32 s34, 2
    s_cselect_b32 s30, 16, s30
    s_cmp_eq_u32 s34, 16
    s_cselect_b32 s30, 2, s30
    s_cmp_eq_u32 s34, 4
    s_cselect_b32 s30, 25, s30
    s_cmp_eq_u32 s34, 25
    s_cselect_b32 s30, 4, s30
    s_cmp_lt_u32 s34, 26
    s_cbranch_scc1 L_twoc
    s_sub_u32 s56, s34, 26
    s_lshr_b32 s57, s56, 1
    s_mul_i32 s57, s57, 3
    s_and_b32 s56, s56, 1
    s_lshl_b32 s56, s56, 1
    s_add_u32 s56, s56, s57
    s_add_u32 s57, s57, 1
    s_mov_b32 s52, 2
    s_mul_i32 s59, s33, 18
    s_add_u32 s58, s33, 16
    s_branch L_tdonec
L_twoc:
    s_cmp_lt_u32 s30, 8
    s_cselect_b32 s52, 3, 1
    s_cselect_b32 s56, 8, s30
    s_cmp_ge_u32 s56, 17
    s_cselect_b32 s57, 17, 8
    s_cselect_b32 s58, 1, 0
    s_sub_u32 s56, s56, s57
    s_lshl_b32 s57, s33, 1
    s_add_u32 s58, s58, s57
    s_mov_b32 s59, s58
    s_lshl_b32 s59, s59, 3
L_tdonec:
    s_lshl_b32 s56, s56, 2
    s_lshl_b32 s57, s57, 2
    s_and_b32 s55, s34, 1
    s_add_u32 s57, s57, s55
    s_cmp_ge_u32 s35, 4
    s_cselect_b32 s56, s57, s56
    s_lshl_b32 s56, s56, 3
    s_add_u32 s56, s56, s58
    s_lshl_b32 s50, s56, 10
    s_add_u32 s50, s50, 655360
    s_lshl_b32 s51, s58, 14
    s_lshl_b32 s57, s35, 7
    s_add_u32 s51, s51, s57
    s_add_u32 s51, s51, 393216
    s_lshl_b32 s58, s58, 11
    s_add_u32 s58, s58, 327680
    s_mul_i32 s46, s33, 9
    s_add_u32 s46, s46, s35
    s_lshl_b32 s46, s46, 10
    s_add_u32 s46, s46, 131072
    s_add_u32 s47, s46, 73728
    s_cmp_eq_u32 s52, 2
    s_cselect_b32 s46, s46, s58
    s_mov_b32 s55, 0xffffff00
    s_mov_b32 s54, 6400000
    v_lshlrev_b32 v13, 4, v0
    v_mov_b32 v9, 0xff
    s_lshl_b32 s56, s35, 2
    v_mov_b32 v4, s56
    v_lshlrev_b32 v12, 2, v0
    v_min_u32 v12, 32, v12
    s_lshl_b32 s56, s35, 12
    s_add_u32 s56, s56, 81920
    v_add_u32 v2, s56, v13
    s_and_b32 s56, s35, 3
    s_lshl_b32 s56, s56, 8
    v_and_b32 v1, 31, v0
    v_lshl_add_u32 v1, v1, 3, s56
    v_and_b32 v10, 3, v0
    v_lshlrev_b32 v5, 6, v14
    v_lshl_add_u32 v5, v10, 4, v5
    v_add_u32 v6, s56, v5
    v_lshrrev_b32 v8, 3, v0
    v_lshlrev_b32 v8, 11, v8
    v_and_b32 v10, 7, v0
    v_lshl_add_u32 v8, v10, 4, v8
    v_lshlrev_b32 v7, 7, v15
    v_and_b32 v10, 1, v14
    v_lshl_add_u32 v7, v10, 6, v7
    s_waitcnt lgkmcnt(0)
    s_mul_i32 s32, s32, 1664525
    s_mul_i32 s94, s94, 0x9e3779b1
    s_add_u32 s94, s94, s95
    s_lshl1_add_u32 s32, s94, s32
    s_add_u32 s32, s32, 1013904223
    s_bfe_u32 s19, s32, 0x80000
    s_bfe_u32 s37, s32, 0x80008
    s_bfe_u32 s38, s32, 0x80010
    s_bfe_u32 s39, s32, 0x80018
    s_cmp_lg_u32 s35, 8
    s_cbranch_scc1 L_nohello
    s_getreg_b32 s56, hwreg(HW_REG_XCC_ID, 0, 4)
    s_xor_b32 s44, s32, s56
    s_lshl_b32 s56, s53, 2
    s_add_u32 s56, s56, 32768
    v_mov_b32 v10, s44
    s_mov_b64 exec, 1
    buffer_store_dword v10, v3, s[20:23], s56 offen
    s_mov_b64 exec, -1
    s_cmp_ge_u32 s34, 26
    s_cbranch_scc1 L_pub_ns
    s_waitcnt vmcnt(2)
    s_branch L_ln
L_nohello:
    s_cmp_lt_u32 s34, 26
    s_waitcnt vmcnt(2)
    s_cbranch_scc1 L_ln
    s_cmp_lt_u32 s35, 4
    s_cbranch_scc1 L_sdone
    v_lshrrev_b32 v14, 5, v0
    v_lshl_add_u32 v14, v14, 10, v1
L_w_7:
    ds_read_b32 v10, v3 offset:360
    s_sub_u32 s54, s54, 1
    s_cbranch_scc1 L_end
    s_waitcnt lgkmcnt(0)
    v_cmp_gt_i32 vcc, 18, v10
    s_cbranch_vccnz L_w_7
    ds_read_b64_tr_b16 v[88:89], v14 offset:8192
    ds_read_b64_tr_b16 v[90:91], v14 offset:10240
    ds_read_b64_tr_b16 v[92:93], v14 offset:12288
    ds_read_b64_tr_b16 v[94:95], v14 offset:14336
    ds_read_b64_tr_b16 v[96:97], v14 offset:16384
    ds_read_b64_tr_b16 v[98:99], v14 offset:18432
    ds_read_b64_tr_b16 v[100:101], v14 offset:20480
    ds_read_b64_tr_b16 v[102:103], v14 offset:22528
    ds_read_b64_tr_b16 v[104:105], v14 offset:24576
    ds_read_b64_tr_b16 v[106:107], v14 offset:26624
    s_waitcnt lgkmcnt(4)
    ds_read_b64_tr_b16 v[108:109], v14 offset:28672
    ds_read_b64_tr_b16 v[110:111], v14 offset:30720
    ds_read_b64_tr_b16 v[112:113], v14 offset:32768
    ds_read_b64_tr_b16 v[114:115], v14 offset:34816
    ds_read_b64_tr_b16 v[116:117], v14 offset:36864
    ds_read_b64_tr_b16 v[118:119], v14 offset:38912
    ds_read_b64_tr_b16 v[120:121], v14 offset:40960
    ds_read_b64_tr_b16 v[122:123], v14 offset:43008
    s_branch L_sdone
L_ln:
    v_lshlrev_b32 v80, 16, v72
    v_and_b32 v81, 0xffff0000, v72
    v_lshlrev_b32 v82, 16, v73
    v_and_b32 v83, 0xffff0000, v73
    v_lshlrev_b32 v76, 16, v76
    v_sub_f32 v84, v80, v76
    v_sub_f32 v85, v81, v76
    v_sub_f32 v86, v82, v76
    v_sub_f32 v87, v83, v76
    v_add_f32 v72, v84, v85
    v_mul_f32 v73, v84, v84
    v_add_f32 v72, v72, v86
    v_fmac_f32 v73, v85, v85
    v_add_f32 v72, v72, v87
    v_fmac_f32 v73, v86, v86
    v_fmac_f32 v73, v87, v87
    v_mul_u32_u24 v74, 80, v14
    v_lshl_add_u32 v75, v4, 1, v74
    v_add_f32_dpp v72, v72, v72 row_ror:8 row_mask:0xf bank_mask:0xf
    v_add_f32_dpp v73, v73, v73 row_ror:8 row_mask:0xf bank_mask:0xf
    s_nop 0
    v_add_f32_dpp v72, v72, v72 row_ror:4 row_mask:0xf bank_mask:0xf
    v_add_f32_dpp v73, v73, v73 row_ror:4 row_mask:0xf bank_mask:0xf
    s_nop 0
    v_add_f32_dpp v72, v72, v72 row_ror:2 row_mask:0xf bank_mask:0xf
    v_add_f32_dpp v73, v73, v73 row_ror:2 row_mask:0xf bank_mask:0xf
    s_nop 0
    v_add_f32_dpp v72, v72, v72 row_ror:1 row_mask:0xf bank_mask:0xf
    v_add_f32_dpp v73, v73, v73 row_ror:1 row_mask:0xf bank_mask:0xf
    ds_write_b64 v75, v[72:73] offset:0
    v_mov_b32 v10, 1
    ds_write_b32 v4, v10 offset:320
    s_lshl_b32 s56, s35, 1
    s_sub_u32 s56, s56, s40
    v_bfe_u32 v15, v0, 3, 1
    v_add_u32 v15, s56, v15
    v_add_u32 v11, 18, v15
    v_min_u32 v15, v15, v11
    v_and_b32 v11, 3, v0
    v_lshl_add_u32 v15, v15, 2, v11
    v_lshl_add_u32 v15, v15, 2, v14
    v_bfe_u32 v11, v0, 2, 1
    v_lshl_add_u32 v15, v15, 1, v11
    v_lshlrev_b32 v75, 3, v15
L_w_8:
    ds_read_b32 v10, v12 offset:320
    ds_read_b128 v[40:43], v74 offset:0
    ds_read_b128 v[44:47], v74 offset:16
    ds_read_b128 v[48:51], v74 offset:32
    ds_read_b128 v[52:55], v74 offset:48
    ds_read_b64 v[56:57], v74 offset:64
    s_sub_u32 s54, s54, 1
    s_cbranch_scc1 L_end
    s_waitcnt lgkmcnt(0)
    v_cmp_gt_i32 vcc, 1, v10
    s_cbranch_vccnz L_w_8
    v_pk_add_f32 v[40:41], v[40:41], v[42:43]
    v_pk_add_f32 v[40:41], v[40:41], v[44:45]
    v_pk_add_f32 v[40:41], v[40:41], v[46:47]
    v_pk_add_f32 v[40:41], v[40:41], v[48:49]
    v_pk_add_f32 v[40:41], v[40:41], v[50:51]
    v_pk_add_f32 v[40:41], v[40:41], v[52:53]
    v_pk_add_f32 v[40:41], v[40:41], v[54:55]
    v_pk_add_f32 v[40:41], v[40:41], v[56:57]
    v_mul_f32 v14, 0x3ae38e39, v40
    v_mul_f32 v15, 0x3ae38e39, v41
    v_fma_f32 v15, -v14, v14, v15
    v_max_f32 v15, 0, v15
    v_add_f32 v14, v14, v76
    v_cvt_pk_bf16_f32 v14, 0, v14
    v_cvt_pk_bf16_f32 v15, 0, v15
    v_add_f32 v15, 0x37280000, v15
    v_cvt_pk_bf16_f32 v15, 0, v15
    v_sqrt_f32 v15, v15
    v_sub_f32 v80, v80, v14
    v_sub_f32 v81, v81, v14
    v_sub_f32 v82, v82, v14
    v_sub_f32 v83, v83, v14
    v_cvt_pk_bf16_f32 v15, 0, v15
    v_rcp_f32 v15, v15
    v_cvt_pk_bf16_f32 v80, 0, v80
    v_cvt_pk_bf16_f32 v81, 0, v81
    v_cvt_pk_bf16_f32 v82, 0, v82
    v_cvt_pk_bf16_f32 v83, 0, v83
    v_mul_f32 v80, v80, v15
    v_mul_f32 v81, v81, v15
    v_mul_f32 v82, v82, v15
    v_mul_f32 v83, v83, v15
    v_cvt_pk_bf16_f32 v72, v80, v81
    v_cvt_pk_bf16_f32 v73, v82, v83
    ds_write_b64 v75, v[72:73] offset:2048
    s_cmp_eq_u32 s35, 8
    s_cbranch_scc1 L_pub_s
    s_cmp_ge_u32 s35, 4
    s_cbranch_scc1 L_sdone
    v_mov_b32 v10, 2
    ds_write_b32 v4, v10 offset:320
    v_lshrrev_b32 v14, 5, v0
    v_lshl_add_u32 v14, v14, 10, v1
    v_add_u32 v14, 8192, v14
    v_mov_b32 v15, v5
    v_and_b32 v10, 3, v0
    v_lshrrev_b32 v11, 6, v6
    v_lshlrev_b32 v11, 4, v11
    v_lshl_add_u32 v11, v10, 14, v11
    s_cmp_lt_u32 s34, 8
    s_cselect_b64 vcc, -1, 0
    v_cndmask_b32 v72, v6, v11, vcc
L_w_9:
    ds_read_b32 v10, v12 offset:320
    s_sub_u32 s54, s54, 1
    s_cbranch_scc1 L_end
    s_waitcnt lgkmcnt(0)
    v_cmp_gt_i32 vcc, 2, v10
    s_cbranch_vccnz L_w_9
    s_mov_b32 s36, 1
    v_pk_mov_b32 v[24:25], 0, 0
    v_pk_mov_b32 v[26:27], 0, 0
    s_branch L_g1_12
L_g_10:
    v_readfirstlane_b32 s41, v10
    s_add_u32 s43, s36, 2
    s_min_i32 s41, s41, 18
    s_cmp_lt_i32 s41, s43
    s_cbranch_scc1 L_g1_12
    ds_read_b64_tr_b16 v[132:133], v14 offset:0
    ds_read_b64_tr_b16 v[134:135], v14 offset:2048
    ds_read_b128 v[136:139], v15 offset:2048
    ds_read_b64_tr_b16 v[140:141], v14 offset:4096
    ds_read_b64_tr_b16 v[142:143], v14 offset:6144
    ds_read_b128 v[144:147], v15 offset:2304
    ds_read_b64_tr_b16 v[148:149], v14 offset:8192
    ds_read_b64_tr_b16 v[150:151], v14 offset:10240
    ds_read_b128 v[152:155], v15 offset:2560
    ds_read_b64 v[10:11], v3 offset:360
    v_add_u32 v14, 12288, v14
    v_add_u32 v15, 768, v15
    s_add_u32 s36, s36, 3
    s_cmp_le_u32 s36, 18
    s_waitcnt lgkmcnt(7)
    v_mfma_f32_16x16x32_bf16 v[24:27], v[132:135], v[136:139], v[24:27]
    s_waitcnt lgkmcnt(4)
    v_mfma_f32_16x16x32_bf16 v[24:27], v[140:143], v[144:147], v[24:27]
    s_waitcnt lgkmcnt(0)
    v_mfma_f32_16x16x32_bf16 v[24:27], v[148:151], v[152:155], v[24:27]
    s_cbranch_scc1 L_g_10
    s_branch L_ge_13
L_g1_12:
    ds_read_b128 v[20:23], v15 offset:2048
L_w_11:
    ds_read_b64 v[10:11], v3 offset:360
    ds_read_b64_tr_b16 v[16:17], v14 offset:0
    ds_read_b64_tr_b16 v[18:19], v14 offset:2048
    s_sub_u32 s54, s54, 1
    s_cbranch_scc1 L_end
    s_waitcnt lgkmcnt(2)
    v_cmp_gt_i32 vcc, s36, v10
    s_cbranch_vccnz L_w_11
    s_waitcnt lgkmcnt(0)
    v_mfma_f32_16x16x32_bf16 v[24:27], v[16:19], v[20:23], v[24:27]
    v_add_u32 v14, 4096, v14
    v_add_u32 v15, 256, v15
    s_add_u32 s36, s36, 1
    s_cmp_le_u32 s36, 18
    s_cbranch_scc1 L_g_10
L_ge_13:
    v_readfirstlane_b32 s43, v11
    s_cmp_eq_u32 s43, 0
    s_cbranch_scc0 L_fknown
L_w_14:
    ds_read_b32 v10, v3 offset:364
    s_sub_u32 s54, s54, 1
    s_cbranch_scc1 L_end
    s_waitcnt lgkmcnt(0)
    v_cmp_gt_i32 vcc, 1, v10
    s_cbranch_vccnz L_w_14
    v_readfirstlane_b32 s43, v10
L_fknown:
    s_mov_b32 exec_lo, 0x000f000f
    s_mov_b32 exec_hi, 0x000f000f
    s_cmp_eq_u32 s43, 2
    v_cvt_pk_bf16_f32 v24, 0, v24
    v_cvt_pk_bf16_f32 v25, 0, v25
    v_cvt_pk_bf16_f32 v26, 0, v26
    v_cvt_pk_bf16_f32 v27, 0, v27
    v_or_b32 v24, s19, v24
    v_or_b32 v25, s37, v25
    v_or_b32 v26, s38, v26
    v_or_b32 v27, s39, v27
    s_cbranch_scc0 L_ps_15
    buffer_store_dwordx4 v[24:27], v72, s[20:23], s49 offen
    s_branch L_pe_16
L_ps_15:
    buffer_store_dwordx4 v[24:27], v72, s[20:23], s49 offen sc1
L_pe_16:
    s_mov_b64 exec, -1
L_sdone:
    v_mov_b32 v10, 3
    ds_write_b32 v4, v10 offset:320
    v_bfe_u32 v14, v0, 3, 1
    v_lshrrev_b32 v15, 4, v0
    v_lshl_add_u32 v80, v14, 3, v15
    v_and_b32 v81, 1, v0
    v_lshl_add_u32 v80, v80, 1, v81
    v_lshlrev_b32 v81, 4, v80
    v_lshlrev_b32 v85, 5, v14
    v_add_u32 v82, v85, v4
    v_mov_b32 v83, 0x3db504f3
    s_lshr_b32 s56, s35, 1
    s_lshl_b32 s56, s56, 7
    s_and_b32 s57, s35, 1
    s_lshl_b32 s57, s57, 3
    s_add_u32 s56, s56, s57
    s_add_u32 s56, s56, 1024
    v_bfe_u32 v10, v0, 2, 1
    v_lshl_add_u32 v84, v10, 9, s56
    v_and_b32 v10, 32, v0
    v_add_u32 v84, v84, v10
    v_lshl_add_u32 v84, v14, 4, v84
    v_and_b32 v10, 1, v15
    v_lshl_add_u32 v84, v10, 2, v84
    s_mov_b32 s56, 0x3fb8aa3b
    s_add_u32 s36, s35, 27
L_w_17:
    ds_read_b32 v10, v3 offset:360
    s_sub_u32 s54, s54, 1
    s_cbranch_scc1 L_end
    s_waitcnt lgkmcnt(0)
    v_cmp_gt_i32 vcc, s36, v10
    s_cbranch_vccnz L_w_17
    ds_read_b128 v[40:43], v2 offset:0
    ds_read_b128 v[44:47], v2 offset:1024
    ds_read_b128 v[48:51], v2 offset:2048
    ds_read_b128 v[52:55], v2 offset:3072
    ds_read_b128 v[56:59], v2 offset:32768
    ds_read_b128 v[60:63], v2 offset:33792
    ds_read_b128 v[64:67], v2 offset:34816
    ds_read_b128 v[68:71], v2 offset:35840
    v_mov_b32 v10, 4
    ds_write_b32 v4, v10 offset:320
L_w_18:
    ds_read_b32 v10, v3 offset:356
    ds_read_b128 v[16:19], v81 offset:512
    ds_read_b128 v[20:23], v81 offset:640
    s_sub_u32 s54, s54, 1
    s_cbranch_scc1 L_end
    s_waitcnt lgkmcnt(0)
    v_cmp_gt_i32 vcc, 1, v10
    s_cbranch_vccnz L_w_18
    v_mfma_f32_16x16x32_bf16 v[24:27], v[40:43], v[16:19], 0
    v_mfma_f32_16x16x32_bf16 v[28:31], v[48:51], v[16:19], 0
    v_mfma_f32_16x16x32_bf16 v[32:35], v[56:59], v[16:19], 0
    v_mfma_f32_16x16x32_bf16 v[36:39], v[64:67], v[16:19], 0
    v_mfma_f32_16x16x32_bf16 v[24:27], v[44:47], v[20:23], v[24:27]
    v_mfma_f32_16x16x32_bf16 v[28:31], v[52:55], v[20:23], v[28:31]
    v_mfma_f32_16x16x32_bf16 v[32:35], v[60:63], v[20:23], v[32:35]
    v_mfma_f32_16x16x32_bf16 v[36:39], v[68:71], v[20:23], v[36:39]
    s_nop 4
    v_add_f32_dpp v72, v25, v24 quad_perm:[1,1,3,3] row_mask:0xf bank_mask:0x5
    v_add_f32_dpp v73, v27, v26 quad_perm:[1,1,3,3] row_mask:0xf bank_mask:0x5
    v_add_f32_dpp v74, v29, v28 quad_perm:[1,1,3,3] row_mask:0xf bank_mask:0x5
    v_add_f32_dpp v75, v31, v30 quad_perm:[1,1,3,3] row_mask:0xf bank_mask:0x5
    v_add_f32_dpp v72, v33, v32 quad_perm:[1,1,3,3] row_mask:0xf bank_mask:0xa
    v_add_f32_dpp v73, v35, v34 quad_perm:[1,1,3,3] row_mask:0xf bank_mask:0xa
    v_add_f32_dpp v74, v37, v36 quad_perm:[1,1,3,3] row_mask:0xf bank_mask:0xa
    v_add_f32_dpp v75, v39, v38 quad_perm:[1,1,3,3] row_mask:0xf bank_mask:0xa
    v_cvt_pk_bf16_f32 v72, 0, v72
    v_cvt_pk_bf16_f32 v73, 0, v73
    v_cvt_pk_bf16_f32 v74, 0, v74
    v_cvt_pk_bf16_f32 v75, 0, v75
    v_mul_f32_dpp v72, v72, v83 quad_perm:[0,0,2,2] row_mask:0xf bank_mask:0xf
    v_mul_f32_dpp v73, v73, v83 quad_perm:[0,0,2,2] row_mask:0xf bank_mask:0xf
    v_mul_f32_dpp v74, v74, v83 quad_perm:[0,0,2,2] row_mask:0xf bank_mask:0xf
    v_mul_f32_dpp v75, v75, v83 quad_perm:[0,0,2,2] row_mask:0xf bank_mask:0xf
    v_cvt_pk_bf16_f32 v72, 0, v72
    v_cvt_pk_bf16_f32 v73, 0, v73
    v_cvt_pk_bf16_f32 v74, 0, v74
    v_cvt_pk_bf16_f32 v75, 0, v75
    v_max3_f32 v14, v72, v73, v74
    v_max_f32 v14, v14, v75
    s_nop 1
    v_max_f32_dpp v14, v14, v14 row_half_mirror row_mask:0xf bank_mask:0xf
    v_mov_b32 v15, v14
    s_nop 1
    v_permlane32_swap_b32 v14, v15
    v_max_f32 v14, v14, v15
    v_mov_b32 v15, v14
    s_nop 1
    v_permlane16_swap_b32 v14, v15
    v_max_f32 v14, v14, v15
    v_sub_f32 v72, v72, v14
    v_sub_f32 v73, v73, v14
    v_sub_f32 v74, v74, v14
    v_sub_f32 v75, v75, v14
    v_mul_f32 v72, s56, v72
    v_mul_f32 v73, s56, v73
    v_mul_f32 v74, s56, v74
    v_mul_f32 v75, s56, v75
    v_exp_f32 v72, v72
    v_exp_f32 v73, v73
    v_exp_f32 v74, v74
    v_exp_f32 v75, v75
    v_add_f32 v15, v72, v73
    v_add_f32 v80, v74, v75
    v_add_f32 v15, v15, v80
    s_nop 1
    v_add_f32_dpp v15, v15, v15 row_half_mirror row_mask:0xf bank_mask:0xf
    v_mov_b32 v80, v15
    s_nop 1
    v_permlane32_swap_b32 v15, v80
    v_add_f32 v15, v15, v80
    v_mov_b32 v80, v15
    s_nop 1
    v_permlane16_swap_b32 v15, v80
    v_add_f32 v15, v15, v80
    ds_write2_b32 v82, v14, v15 offset0:96 offset1:112
    v_mov_b32 v10, 5
    ds_write_b32 v4, v10 offset:320
L_w_19:
    ds_read_b32 v10, v12 offset:320
    ds_read_b128 v[16:19], v85 offset:384
    ds_read_b128 v[20:23], v85 offset:400
    s_sub_u32 s54, s54, 1
    s_cbranch_scc1 L_end
    s_waitcnt lgkmcnt(0)
    v_cmp_gt_i32 vcc, 5, v10
    s_cbranch_vccnz L_w_19
    v_max3_f32 v15, v16, v17, v18
    v_max3_f32 v11, v19, v20, v21
    v_max3_f32 v15, v15, v22, v23
    v_max_f32 v15, v15, v11
    v_sub_f32 v14, v14, v15
    v_mul_f32 v14, s56, v14
    v_exp_f32 v14, v14
    s_nop 0
    v_mul_f32 v72, v72, v14
    v_mul_f32 v73, v73, v14
    v_mul_f32 v74, v74, v14
    v_mul_f32 v75, v75, v14
    v_cvt_pk_bf16_f32 v72, v72, v73
    v_cvt_pk_bf16_f32 v74, v74, v75
    ds_write2_b32 v84, v72, v74 offset0:0 offset1:16
    v_mov_b32 v10, 6
    ds_write_b32 v4, v10 offset:320
    s_lshr_b32 s57, s35, 2
    s_lshl_b32 s57, s57, 10
    s_add_u32 s57, s57, 8192
    v_lshrrev_b32 v14, 5, v0
    v_lshl_add_u32 v14, v14, 11, v1
    v_add_u32 v14, s57, v14
    v_lshrrev_b32 v11, 4, v0
    v_and_b32 v10, 1, v0
    v_lshl_add_u32 v15, v11, 1, v10
    v_lshlrev_b32 v15, 4, v15
    v_lshl_add_u32 v80, v10, 2, v11
    v_lshlrev_b32 v80, 4, v80
    s_lshl_b32 s57, s53, 3
    s_add_u32 s57, s57, s35
    s_lshl_b32 s57, s57, 7
    s_add_u32 s57, s57, 393216
    s_cmp_lg_u32 s52, 2
    s_cbranch_scc1 L_noaux
L_w_20:
    ds_read_b32 v10, v3 offset:360
    s_sub_u32 s54, s54, 1
    s_cbranch_scc1 L_end
    s_waitcnt lgkmcnt(0)
    v_cmp_gt_i32 vcc, 44, v10
    s_cbranch_vccnz L_w_20
    buffer_load_dwordx4 v[124:127], v13, s[20:23], s46 offen sc1
    buffer_load_dwordx4 v[128:131], v13, s[20:23], s47 offen sc1
L_noaux:
L_w_21:
    ds_read_b32 v10, v12 offset:320
    s_sub_u32 s54, s54, 1
    s_cbranch_scc1 L_end
    s_waitcnt lgkmcnt(0)
    v_cmp_gt_i32 vcc, 6, v10
    s_cbranch_vccnz L_w_21
    s_mov_b32 s36, 36
    v_pk_mov_b32 v[24:25], 0, 0
    v_pk_mov_b32 v[26:27], 0, 0
    s_branch L_g1_24
L_g_22:
    v_readfirstlane_b32 s41, v10
    s_add_u32 s43, s36, 4
    s_min_i32 s41, s41, 50
    s_cmp_lt_i32 s41, s43
    s_cbranch_scc1 L_g1_24
    ds_read_b64_tr_b16 v[132:133], v14 offset:0
    ds_read_b64_tr_b16 v[134:135], v14 offset:4096
    ds_read_b128 v[136:139], v15 offset:1024
    ds_read_b64_tr_b16 v[140:141], v14 offset:8192
    ds_read_b64_tr_b16 v[142:143], v14 offset:12288
    ds_read_b128 v[144:147], v15 offset:1152
    ds_read_b64_tr_b16 v[148:149], v14 offset:16384
    ds_read_b64_tr_b16 v[150:151], v14 offset:20480
    ds_read_b128 v[152:155], v15 offset:1280
    ds_read_b64 v[10:11], v3 offset:360
    v_add_u32 v14, 24576, v14
    v_add_u32 v15, 384, v15
    s_add_u32 s36, s36, 6
    s_cmp_le_u32 s36, 50
    s_waitcnt lgkmcnt(7)
    v_mfma_f32_16x16x32_bf16 v[24:27], v[132:135], v[136:139], v[24:27]
    s_waitcnt lgkmcnt(4)
    v_mfma_f32_16x16x32_bf16 v[24:27], v[140:143], v[144:147], v[24:27]
    s_waitcnt lgkmcnt(0)
    v_mfma_f32_16x16x32_bf16 v[24:27], v[148:151], v[152:155], v[24:27]
    s_cbranch_scc1 L_g_22
    s_branch L_ge_25
L_g1_24:
    ds_read_b128 v[20:23], v15 offset:1024
L_w_23:
    ds_read_b64 v[10:11], v3 offset:360
    ds_read_b64_tr_b16 v[16:17], v14 offset:0
    ds_read_b64_tr_b16 v[18:19], v14 offset:4096
    s_sub_u32 s54, s54, 1
    s_cbranch_scc1 L_end
    s_waitcnt lgkmcnt(2)
    v_cmp_gt_i32 vcc, s36, v10
    s_cbranch_vccnz L_w_23
    s_waitcnt lgkmcnt(0)
    v_mfma_f32_16x16x32_bf16 v[24:27], v[16:19], v[20:23], v[24:27]
    v_add_u32 v14, 8192, v14
    v_add_u32 v15, 128, v15
    s_add_u32 s36, s36, 2
    s_cmp_le_u32 s36, 50
    s_cbranch_scc1 L_g_22
L_ge_25:
    v_readfirstlane_b32 s43, v11
    s_mov_b32 exec_lo, 0x00030003
    s_mov_b32 exec_hi, 0x00030003
    s_cmp_eq_u32 s43, 2
    s_nop 1
    v_bfi_b32 v24, v9, s19, v24
    v_bfi_b32 v25, v9, s37, v25
    v_bfi_b32 v26, v9, s38, v26
    v_bfi_b32 v27, v9, s39, v27
    s_cbranch_scc0 L_ps_26
    buffer_store_dwordx4 v[24:27], v80, s[20:23], s57 offen
    s_branch L_pe_27
L_ps_26:
    buffer_store_dwordx4 v[24:27], v80, s[20:23], s57 offen sc1
L_pe_27:
    s_mov_b64 exec, -1
    s_cmp_eq_u32 s52, 3
    s_cbranch_scc1 L_reduce
    s_and_b32 s56, s35, 3
    s_lshl_b32 s56, s56, 1
    s_cmp_eq_u32 s43, 2
    s_cselect_b32 s57, 983055, 0
    s_cmp_eq_u32 s56, s33
    s_cselect_b32 s14, s57, 0
    s_add_u32 s56, s56, 1
    s_cmp_eq_u32 s56, s33
    s_cselect_b32 s15, s57, 0
    s_xor_b32 s12, s14, 0x000f000f
    s_xor_b32 s13, s15, 0x000f000f
    v_lshrrev_b32 v14, 5, v0
    v_lshl_add_u32 v14, v14, 10, v1
    v_add_u32 v14, 73728, v14
    s_cmp_eq_u32 s52, 2
    s_cbranch_scc1 L_term_dn
    v_bfe_u32 v10, v0, 2, 1
    v_lshrrev_b32 v11, 3, v0
    v_lshl_add_u32 v88, v10, 3, v11
    v_lshlrev_b32 v88, 3, v88
    v_and_b32 v89, 3, v0
    v_add_u32 v89, v89, v4
    v_lshrrev_b32 v11, 4, v0
    v_lshl_add_u32 v89, v89, 2, v11
    v_lshl_add_u32 v89, v89, 1, v10
    v_lshlrev_b32 v89, 3, v89
    s_mov_b64 s[4:5], -1
    s_mov_b64 s[6:7], -1
L_w_28:
    ds_read_b32 v10, v3 offset:360
    s_sub_u32 s54, s54, 1
    s_cbranch_scc1 L_end
    s_waitcnt lgkmcnt(0)
    v_cmp_gt_i32 vcc, 56, v10
    s_cbranch_vccnz L_w_28
    buffer_load_dwordx4 v[72:75], v8, s[20:23], s51 offen sc1
    buffer_load_dwordx4 v[76:79], v8, s[20:23], s51 offen offset:1024 sc1
    s_cmp_ge_u32 s35, 4
    s_cbranch_scc1 L_opoll
    ds_read_b64_tr_b16 v[40:41], v14 offset:0
    ds_read_b64_tr_b16 v[42:43], v14 offset:2048
    ds_read_b64_tr_b16 v[44:45], v14 offset:4096
    ds_read_b64_tr_b16 v[46:47], v14 offset:6144
    ds_read_b64_tr_b16 v[48:49], v14 offset:8192
    ds_read_b64_tr_b16 v[50:51], v14 offset:10240
    ds_read_b64_tr_b16 v[52:53], v14 offset:12288
    ds_read_b64_tr_b16 v[54:55], v14 offset:14336
    ds_read_b64_tr_b16 v[56:57], v14 offset:16384
    ds_read_b64_tr_b16 v[58:59], v14 offset:18432
    ds_read_b64_tr_b16 v[60:61], v14 offset:20480
    ds_read_b64_tr_b16 v[62:63], v14 offset:22528
    s_waitcnt lgkmcnt(4)
L_t58:
L_w_29:
    ds_read_b32 v10, v3 offset:360
    ds_read_b64_tr_b16 v[64:65], v14 offset:24576
    ds_read_b64_tr_b16 v[66:67], v14 offset:26624
    ds_read_b64_tr_b16 v[68:69], v14 offset:28672
    ds_read_b64_tr_b16 v[70:71], v14 offset:30720
    ds_read_b32 v11, v3 offset:368
    ds_read_b64 v[90:91], v88 offset:0
    s_sub_u32 s54, s54, 1
    s_cbranch_scc1 L_end
    s_waitcnt lgkmcnt(0)
    v_cmp_gt_i32 vcc, 58, v10
    s_cbranch_vccnz L_w_29
L_ochk:
    v_cmp_eq_u32 vcc, 0, v11
    s_waitcnt vmcnt(0)
    v_xor_b32 v80, s19, v72
    v_xor_b32 v81, s37, v73
    v_xor_b32 v82, s38, v74
    v_xor_b32 v83, s39, v75
    v_xor_b32 v84, s19, v76
    v_xor_b32 v85, s37, v77
    v_xor_b32 v86, s38, v78
    v_xor_b32 v87, s39, v79
    v_or3_b32 v10, v80, v81, v82
    v_or3_b32 v11, v84, v85, v86
    v_bitop3_b32 v10, v10, v83, v9 bitop3:0xa8
    v_bitop3_b32 v11, v11, v87, v9 bitop3:0xa8
    v_cmp_ne_u32 s[4:5], 0, v10
    v_cmp_ne_u32 s[6:7], 0, v11
    v_pk_mul_f32 v[80:81], v[80:81], v[90:91] op_sel:[0,0] op_sel_hi:[1,0]
    v_pk_mul_f32 v[82:83], v[82:83], v[90:91] op_sel:[0,0] op_sel_hi:[1,0]
    s_or_b64 vcc, vcc, s[4:5]
    s_or_b64 vcc, vcc, s[6:7]
    s_cbranch_scc1 L_oretry
    v_pk_fma_f32 v[80:81], v[84:85], v[90:91], v[80:81] op_sel:[0,1,0] op_sel_hi:[1,1,1]
    v_pk_fma_f32 v[82:83], v[86:87], v[90:91], v[82:83] op_sel:[0,1,0] op_sel_hi:[1,1,1]
    s_cmp_ge_u32 s35, 4
    v_add_f32_dpp v80, v80, v80 row_ror:8 row_mask:0xf bank_mask:0xf
    v_add_f32_dpp v81, v81, v81 row_ror:8 row_mask:0xf bank_mask:0xf
    v_add_f32_dpp v82, v82, v82 row_ror:8 row_mask:0xf bank_mask:0xf
    v_add_f32_dpp v83, v83, v83 row_ror:8 row_mask:0xf bank_mask:0xf
    v_cvt_pk_bf16_f32 v80, v80, v81
    v_cvt_pk_bf16_f32 v81, v82, v83
    ds_write_b64 v89, v[80:81] offset:2048
    s_waitcnt lgkmcnt(0)
    s_barrier
    s_cbranch_scc1 L_done
    ds_read_b128 v[124:127], v5 offset:2048
    ds_read_b128 v[128:131], v5 offset:2304
    ds_read_b128 v[132:135], v5 offset:2560
    ds_read_b128 v[136:139], v5 offset:2816
    ds_read_b128 v[140:143], v5 offset:3072
    ds_read_b128 v[144:147], v5 offset:3328
    ds_read_b128 v[148:151], v5 offset:3584
    ds_read_b128 v[152:155], v5 offset:3840
    s_waitcnt lgkmcnt(7)
    v_mfma_f32_16x16x32_bf16 v[24:27], v[40:43], v[124:127], 0
    s_waitcnt lgkmcnt(6)
    v_mfma_f32_16x16x32_bf16 v[24:27], v[44:47], v[128:131], v[24:27]
    s_waitcnt lgkmcnt(5)
    v_mfma_f32_16x16x32_bf16 v[24:27], v[48:51], v[132:135], v[24:27]
    s_waitcnt lgkmcnt(4)
    v_mfma_f32_16x16x32_bf16 v[24:27], v[52:55], v[136:139], v[24:27]
    s_waitcnt lgkmcnt(3)
    v_mfma_f32_16x16x32_bf16 v[24:27], v[56:59], v[140:143], v[24:27]
    s_waitcnt lgkmcnt(2)
    v_mfma_f32_16x16x32_bf16 v[24:27], v[60:63], v[144:147], v[24:27]
    s_waitcnt lgkmcnt(1)
    v_mfma_f32_16x16x32_bf16 v[24:27], v[64:67], v[148:151], v[24:27]
    s_waitcnt lgkmcnt(0)
    v_mfma_f32_16x16x32_bf16 v[24:27], v[68:71], v[152:155], v[24:27]
    s_nop 7
    v_bfi_b32 v24, v9, s19, v24
    v_bfi_b32 v25, v9, s37, v25
    v_bfi_b32 v26, v9, s38, v26
    v_bfi_b32 v27, v9, s39, v27
    s_mov_b64 exec, s[12:13]
    buffer_store_dwordx4 v[24:27], v6, s[20:23], s50 offen sc1
    s_mov_b64 exec, s[14:15]
    s_cbranch_execz L_nsp_30
    buffer_store_dwordx4 v[24:27], v6, s[20:23], s50 offen
L_nsp_30:
    s_endpgm
L_oretry:
    s_and_b64 exec, s[4:5], -1
    s_cbranch_scc0 L_or0
    buffer_load_dwordx4 v[72:75], v8, s[20:23], s51 offen sc1
L_or0:
    s_and_b64 exec, s[6:7], -1
    s_cbranch_scc0 L_or1
    buffer_load_dwordx4 v[76:79], v8, s[20:23], s51 offen offset:1024 sc1
L_or1:
    s_mov_b64 exec, -1
    s_sub_u32 s54, s54, 16
    s_cbranch_scc1 L_end
L_opoll:
    ds_read_b32 v11, v3 offset:368
    ds_read_b64 v[90:91], v88 offset:0
    s_waitcnt lgkmcnt(0)
    s_branch L_ochk
L_term_dn:
    s_waitcnt vmcnt(1)
L_auxchk:
    v_xor_b32 v15, s19, v124
    v_bitop3_b32 v15, v15, v125, s37 bitop3:0xf6
    v_bitop3_b32 v15, v15, v126, s38 bitop3:0xf6
    v_bitop3_b32 v15, v15, v127, s39 bitop3:0xf6
    v_bitop3_b32 v15, v15, v128, s19 bitop3:0xf6
    v_bitop3_b32 v15, v15, v129, s37 bitop3:0xf6
    v_bitop3_b32 v15, v15, v130, s38 bitop3:0xf6
    v_bitop3_b32 v15, v15, v131, s39 bitop3:0xf6
    v_and_b32 v15, 0xff, v15
    v_cmp_ne_u32 vcc, 0, v15
    s_cbranch_vccz L_auxok
    buffer_load_dwordx4 v[124:127], v13, s[20:23], s46 offen sc1
    buffer_load_dwordx4 v[128:131], v13, s[20:23], s47 offen sc1
    s_sub_u32 s54, s54, 64
    s_waitcnt vmcnt(0)
    s_cbranch_scc0 L_auxchk
    s_endpgm
L_auxok:
    s_mov_b32 s56, 0xbdd2d3e8
    v_mov_b32 v15, 0xc0135761
    v_and_b32 v72, 0xffff0000, v124
    v_and_b32 v73, 0xffff0000, v125
    v_and_b32 v74, 0xffff0000, v126
    v_and_b32 v75, 0xffff0000, v127
    v_and_b32 v76, 0xffff0000, v128
    v_and_b32 v77, 0xffff0000, v129
    v_and_b32 v78, 0xffff0000, v130
    v_and_b32 v79, 0xffff0000, v131
    v_mul_f32 v80, v72, v72
    v_mul_f32 v81, v73, v73
    v_mul_f32 v82, v74, v74
    v_mul_f32 v83, v75, v75
    v_fma_f32 v80, v80, s56, v15
    v_fma_f32 v81, v81, s56, v15
    v_fma_f32 v82, v82, s56, v15
    v_fma_f32 v83, v83, s56, v15
    v_mul_f32 v80, v80, v72
    v_mul_f32 v81, v81, v73
    v_mul_f32 v82, v82, v74
    v_mul_f32 v83, v83, v75
    v_exp_f32 v80, v80
    v_exp_f32 v81, v81
    v_exp_f32 v82, v82
    v_exp_f32 v83, v83
    v_add_f32 v80, 1.0, v80
    v_add_f32 v81, 1.0, v81
    v_add_f32 v82, 1.0, v82
    v_add_f32 v83, 1.0, v83
    v_rcp_f32 v80, v80
    v_rcp_f32 v81, v81
    v_rcp_f32 v82, v82
    v_rcp_f32 v83, v83
    v_and_b32 v15, 0xf0, v13
    v_lshl_add_u32 v15, v4, 7, v15
    v_and_b32 v11, 32, v0
    v_lshl_add_u32 v15, v11, 3, v15
    v_bfe_u32 v11, v0, 4, 1
    v_lshl_add_u32 v15, v11, 3, v15
    v_mul_f32 v80, v80, v72
    v_mul_f32 v81, v81, v73
    v_mul_f32 v82, v82, v74
    v_mul_f32 v83, v83, v75
    v_cvt_pk_bf16_f32 v80, 0, v80
    v_cvt_pk_bf16_f32 v81, 0, v81
    v_cvt_pk_bf16_f32 v82, 0, v82
    v_cvt_pk_bf16_f32 v83, 0, v83
    v_mul_f32 v80, v80, v76
    v_mul_f32 v81, v81, v77
    v_mul_f32 v82, v82, v78
    v_mul_f32 v83, v83, v79
    v_cvt_pk_bf16_f32 v72, v80, v81
    v_cvt_pk_bf16_f32 v73, v82, v83
    ds_write_b64 v15, v[72:73] offset:2048
    v_mov_b32 v10, 8
    ds_write_b32 v4, v10 offset:320
    s_cmp_eq_u32 s35, 8
    s_cbranch_scc1 L_done
    v_mov_b32 v15, v5
L_w_31:
    ds_read_b32 v10, v12 offset:320
    s_sub_u32 s54, s54, 1
    s_cbranch_scc1 L_end
    s_waitcnt lgkmcnt(0)
    v_cmp_gt_i32 vcc, 8, v10
    s_cbranch_vccnz L_w_31
    s_cmp_ge_u32 s35, 4
    s_cbranch_scc1 L_term_half
    s_mov_b32 s36, 51
    v_pk_mov_b32 v[24:25], 0, 0
    v_pk_mov_b32 v[26:27], 0, 0
    s_branch L_g1_34
L_g_32:
    v_readfirstlane_b32 s41, v10
    s_add_u32 s43, s36, 2
    s_min_i32 s41, s41, 68
    s_cmp_lt_i32 s41, s43
    s_cbranch_scc1 L_g1_34
    ds_read_b64_tr_b16 v[132:133], v14 offset:0
    ds_read_b64_tr_b16 v[134:135], v14 offset:2048
    ds_read_b128 v[136:139], v15 offset:2048
    ds_read_b64_tr_b16 v[140:141], v14 offset:4096
    ds_read_b64_tr_b16 v[142:143], v14 offset:6144
    ds_read_b128 v[144:147], v15 offset:2304
    ds_read_b64_tr_b16 v[148:149], v14 offset:8192
    ds_read_b64_tr_b16 v[150:151], v14 offset:10240
    ds_read_b128 v[152:155], v15 offset:2560
    ds_read_b64 v[10:11], v3 offset:360
    v_add_u32 v14, 12288, v14
    v_add_u32 v15, 768, v15
    s_add_u32 s36, s36, 3
    s_cmp_le_u32 s36, 68
    s_waitcnt lgkmcnt(7)
    v_mfma_f32_16x16x32_bf16 v[24:27], v[132:135], v[136:139], v[24:27]
    s_waitcnt lgkmcnt(4)
    v_mfma_f32_16x16x32_bf16 v[24:27], v[140:143], v[144:147], v[24:27]
    s_waitcnt lgkmcnt(0)
    v_mfma_f32_16x16x32_bf16 v[24:27], v[148:151], v[152:155], v[24:27]
    s_cbranch_scc1 L_g_32
    s_branch L_ge_35
L_g1_34:
    ds_read_b128 v[20:23], v15 offset:2048
L_w_33:
    ds_read_b64 v[10:11], v3 offset:360
    ds_read_b64_tr_b16 v[16:17], v14 offset:0
    ds_read_b64_tr_b16 v[18:19], v14 offset:2048
    s_sub_u32 s54, s54, 1
    s_cbranch_scc1 L_end
    s_waitcnt lgkmcnt(2)
    v_cmp_gt_i32 vcc, s36, v10
    s_cbranch_vccnz L_w_33
    s_waitcnt lgkmcnt(0)
    v_mfma_f32_16x16x32_bf16 v[24:27], v[16:19], v[20:23], v[24:27]
    v_add_u32 v14, 4096, v14
    v_add_u32 v15, 256, v15
    s_add_u32 s36, s36, 1
    s_cmp_le_u32 s36, 68
    s_cbranch_scc1 L_g_32
L_ge_35:
    v_readfirstlane_b32 s43, v11
    s_nop 4
    v_bfi_b32 v24, v9, s19, v24
    v_bfi_b32 v25, v9, s37, v25
    v_bfi_b32 v26, v9, s38, v26
    v_bfi_b32 v27, v9, s39, v27
    s_mov_b64 exec, s[12:13]
    buffer_store_dwordx4 v[24:27], v6, s[20:23], s50 offen sc1
    s_mov_b64 exec, s[14:15]
    s_cbranch_execz L_nsp_36
    buffer_store_dwordx4 v[24:27], v6, s[20:23], s50 offen
L_nsp_36:
    s_endpgm
L_term_half:
    s_bitcmp1_b32 s34, 0
    s_cselect_b32 s56, 2304, 0
    v_add_u32 v15, s56, v15
    ds_read_b128 v[124:127], v15 offset:2048
    ds_read_b128 v[128:131], v15 offset:2304
    ds_read_b128 v[132:135], v15 offset:2560
    ds_read_b128 v[136:139], v15 offset:2816
    ds_read_b128 v[140:143], v15 offset:3072
    ds_read_b128 v[144:147], v15 offset:3328
    ds_read_b128 v[148:151], v15 offset:3584
    ds_read_b128 v[152:155], v15 offset:3840
    ds_read_b128 v[16:19], v15 offset:4096
    s_waitcnt lgkmcnt(8)
    v_mfma_f32_16x16x32_bf16 v[24:27], v[88:91], v[124:127], 0
    s_waitcnt lgkmcnt(7)
    v_mfma_f32_16x16x32_bf16 v[24:27], v[92:95], v[128:131], v[24:27]
    s_waitcnt lgkmcnt(6)
    v_mfma_f32_16x16x32_bf16 v[24:27], v[96:99], v[132:135], v[24:27]
    s_waitcnt lgkmcnt(5)
    v_mfma_f32_16x16x32_bf16 v[24:27], v[100:103], v[136:139], v[24:27]
    s_waitcnt lgkmcnt(4)
    v_mfma_f32_16x16x32_bf16 v[24:27], v[104:107], v[140:143], v[24:27]
    s_waitcnt lgkmcnt(3)
    v_mfma_f32_16x16x32_bf16 v[24:27], v[108:111], v[144:147], v[24:27]
    s_waitcnt lgkmcnt(2)
    v_mfma_f32_16x16x32_bf16 v[24:27], v[112:115], v[148:151], v[24:27]
    s_waitcnt lgkmcnt(1)
    v_mfma_f32_16x16x32_bf16 v[24:27], v[116:119], v[152:155], v[24:27]
    s_waitcnt lgkmcnt(0)
    v_mfma_f32_16x16x32_bf16 v[24:27], v[120:123], v[16:19], v[24:27]
    s_nop 7
    v_bfi_b32 v24, v9, s19, v24
    v_bfi_b32 v25, v9, s37, v25
    v_bfi_b32 v26, v9, s38, v26
    v_bfi_b32 v27, v9, s39, v27
    s_mov_b64 exec, s[12:13]
    buffer_store_dwordx4 v[24:27], v6, s[20:23], s50 offen sc1
    s_mov_b64 exec, s[14:15]
    s_cbranch_execz L_nsp_37
    buffer_store_dwordx4 v[24:27], v6, s[20:23], s50 offen
L_nsp_37:
    s_endpgm
L_pub_s:
    v_mov_b32 v10, 8
    ds_write_b32 v4, v10 offset:320
    s_and_b32 s56, s2, 15
    s_lshl_b32 s56, s56, 7
    s_add_u32 s56, s56, 36864
    buffer_load_dword v15, v3, s[20:23], s56 offen sc1
L_w_38:
    ds_read_b32 v10, v3 offset:360
    s_sub_u32 s54, s54, 1
    s_cbranch_scc1 L_end
    s_waitcnt lgkmcnt(0)
    v_cmp_gt_i32 vcc, 5, v10
    s_cbranch_vccnz L_w_38
L_hl:
    s_lshl_b32 s56, s33, 7
    s_add_u32 s56, s56, 32768
    v_lshlrev_b32 v11, 2, v0
    v_and_b32 v11, 0x7c, v11
    buffer_load_dword v11, v11, s[20:23], s56 offen sc1
    s_sub_u32 s54, s54, 64
    s_cbranch_scc1 L_end
    s_waitcnt vmcnt(0)
    ds_read_b32 v10, v3 offset:360
    v_cmp_ne_u32 vcc, s44, v11
    s_waitcnt lgkmcnt(0)
    s_cbranch_vccz L_hok
    v_cmp_gt_i32 vcc, 18, v10
    s_cbranch_vccnz L_hl
L_hok:
    v_cmp_ne_u32 vcc, s44, v11
    s_cmp_eq_u64 vcc, 0
    s_cselect_b32 s43, 2, 1
    v_mov_b32 v11, s43
    ds_write_b32 v3, v11 offset:364
    s_lshl_b32 s57, s53, 2
    s_and_b32 s56, s34, 1
    s_lshl_b32 s56, s56, 10
    s_add_u32 s57, s57, s56
    s_add_u32 s57, s57, 36864
    v_mov_b32 v14, s44
    v_lshlrev_b32 v88, 2, v0
    v_and_b32 v88, 0x7c, v88
    s_and_b32 s58, s57, 0xffffff80
    s_xor_b32 s58, s58, 0x400
L_w_39:
    ds_read_b32 v10, v3 offset:360
    s_sub_u32 s54, s54, 1
    s_cbranch_scc1 L_end
    s_waitcnt lgkmcnt(0)
    v_cmp_gt_i32 vcc, 19, v10
    s_cbranch_vccnz L_w_39
    buffer_load_dword v88, v88, s[20:23], s58 offen sc1
L_w_40:
    ds_read_b32 v10, v3 offset:360
    s_sub_u32 s54, s54, 1
    s_cbranch_scc1 L_end
    s_waitcnt lgkmcnt(0)
    v_cmp_gt_i32 vcc, 22, v10
    s_cbranch_vccnz L_w_40
    s_mov_b64 exec, 1
    buffer_store_dword v14, v3, s[20:23], s57 offen
    s_mov_b64 exec, -1
    s_mov_b32 s36, 22
    s_branch L_pub_q
L_pub_ns:
    v_not_b32 v88, s44
    v_mov_b32 v10, 7
    ds_write_b32 v4, v10 offset:320
    s_mov_b32 s36, 31
L_pub_q:
    s_lshl_b32 s59, s53, 7
    s_add_u32 s59, s59, 327680
L_w_41:
    ds_read_b32 v10, v3 offset:360
    s_sub_u32 s54, s54, 1
    s_cbranch_scc1 L_end
    s_waitcnt lgkmcnt(0)
    v_cmp_gt_i32 vcc, s36, v10
    s_cbranch_vccnz L_w_41
    s_lshl_b32 s56, s33, 7
    s_add_u32 s56, s56, 32768
    v_lshlrev_b32 v11, 2, v0
    v_and_b32 v11, 0x7c, v11
    buffer_load_dword v11, v11, s[20:23], s56 offen sc1
    buffer_load_dwordx4 v[132:135], v13, s[20:23], s48 offen sc1
    s_add_u32 s36, s36, 2
L_w_42:
    ds_read_b32 v10, v3 offset:360
    s_sub_u32 s54, s54, 1
    s_cbranch_scc1 L_end
    s_waitcnt lgkmcnt(0)
    v_cmp_gt_i32 vcc, s36, v10
    s_cbranch_vccnz L_w_42
    buffer_load_dwordx4 v[136:139], v13, s[20:23], s48 offen sc1
    s_add_u32 s36, s36, 2
L_w_43:
    ds_read_b32 v10, v3 offset:360
    s_sub_u32 s54, s54, 1
    s_cbranch_scc1 L_end
    s_waitcnt lgkmcnt(0)
    v_cmp_gt_i32 vcc, s36, v10
    s_cbranch_vccnz L_w_43
    buffer_load_dwordx4 v[140:143], v13, s[20:23], s48 offen sc1
    s_waitcnt vmcnt(5)
    v_cmp_eq_u32 vcc, s44, v88
    s_bcnt1_i32_b32 s56, vcc_lo
    s_cmp_lt_u32 s56, 7
    s_cbranch_scc1 L_ontime
    ds_write_b32 v3, v9 offset:372
L_ontime:
    s_mov_b32 s56, 0x07060302
L_qpoll:
    s_sub_u32 s54, s54, 64
    s_cbranch_scc1 L_end
    s_waitcnt vmcnt(2)
    v_xor_b32 v15, s19, v132
    v_bitop3_b32 v15, v15, v133, s37 bitop3:0xf6
    v_bitop3_b32 v15, v15, v134, s38 bitop3:0xf6
    v_bitop3_b32 v15, v15, v135, s39 bitop3:0xf6
    v_and_b32 v15, 0xff, v15
    v_cmp_ne_u32 vcc, 0, v15
    v_perm_b32 v40, v133, v132, s56
    v_perm_b32 v41, v135, v134, s56
    s_cbranch_vccz L_qok
    buffer_load_dwordx4 v[132:135], v13, s[20:23], s48 offen sc1
    s_waitcnt vmcnt(2)
    v_xor_b32 v15, s19, v136
    v_bitop3_b32 v15, v15, v137, s37 bitop3:0xf6
    v_bitop3_b32 v15, v15, v138, s38 bitop3:0xf6
    v_bitop3_b32 v15, v15, v139, s39 bitop3:0xf6
    v_and_b32 v15, 0xff, v15
    v_cmp_ne_u32 vcc, 0, v15
    v_perm_b32 v40, v137, v136, s56
    v_perm_b32 v41, v139, v138, s56
    s_cbranch_vccz L_qok
    buffer_load_dwordx4 v[136:139], v13, s[20:23], s48 offen sc1
    s_waitcnt vmcnt(2)
    v_xor_b32 v15, s19, v140
    v_bitop3_b32 v15, v15, v141, s37 bitop3:0xf6
    v_bitop3_b32 v15, v15, v142, s38 bitop3:0xf6
    v_bitop3_b32 v15, v15, v143, s39 bitop3:0xf6
    v_and_b32 v15, 0xff, v15
    v_cmp_ne_u32 vcc, 0, v15
    v_perm_b32 v40, v141, v140, s56
    v_perm_b32 v41, v143, v142, s56
    s_cbranch_vccz L_qok
    buffer_load_dwordx4 v[140:143], v13, s[20:23], s48 offen sc1
    s_branch L_qpoll
L_qok:
    v_lshlrev_b32 v15, 3, v0
    ds_write_b64 v15, v[40:41] offset:512
    ds_write_b32 v3, v9 offset:356
    v_cmp_ne_u32 vcc, s44, v11
    s_cmp_eq_u64 vcc, 0
    s_cselect_b32 s43, 2, 1
    v_mov_b32 v11, s43
    ds_write_b32 v3, v11 offset:364
    v_lshrrev_b32 v14, 5, v0
    v_lshlrev_b32 v15, 5, v14
L_w_44:
    ds_read_b32 v10, v12 offset:320
    s_sub_u32 s54, s54, 1
    s_cbranch_scc1 L_end
    s_waitcnt lgkmcnt(0)
    v_cmp_gt_i32 vcc, 5, v10
    s_cbranch_vccnz L_w_44
    ds_read_b128 v[40:43], v15 offset:384
    ds_read_b128 v[44:47], v15 offset:400
    ds_read_b128 v[56:59], v15 offset:448
    ds_read_b128 v[60:63], v15 offset:464
    s_mov_b32 s56, 0x3fb8aa3b
    v_lshlrev_b32 v15, 6, v14
    v_and_b32 v10, 3, v0
    v_lshl_add_u32 v15, v10, 4, v15
    s_waitcnt lgkmcnt(0)
    v_max3_f32 v52, v40, v41, v42
    v_max3_f32 v52, v52, v43, v44
    v_max3_f32 v52, v52, v45, v46
    v_max_f32 v52, v52, v47
    v_sub_f32 v40, v40, v52
    v_sub_f32 v41, v41, v52
    v_sub_f32 v42, v42, v52
    v_sub_f32 v43, v43, v52
    v_sub_f32 v44, v44, v52
    v_sub_f32 v45, v45, v52
    v_sub_f32 v46, v46, v52
    v_sub_f32 v47, v47, v52
    v_mul_f32 v40, s56, v40
    v_mul_f32 v41, s56, v41
    v_mul_f32 v42, s56, v42
    v_mul_f32 v43, s56, v43
    v_mul_f32 v44, s56, v44
    v_mul_f32 v45, s56, v45
    v_mul_f32 v46, s56, v46
    v_mul_f32 v47, s56, v47
    v_exp_f32 v40, v40
    v_exp_f32 v41, v41
    v_exp_f32 v42, v42
    v_exp_f32 v43, v43
    v_exp_f32 v44, v44
    v_exp_f32 v45, v45
    v_exp_f32 v46, v46
    v_exp_f32 v47, v47
    v_mul_f32 v53, v40, v56
    v_fmac_f32 v53, v41, v57
    v_fmac_f32 v53, v42, v58
    v_fmac_f32 v53, v43, v59
    v_fmac_f32 v53, v44, v60
    v_fmac_f32 v53, v45, v61
    v_fmac_f32 v53, v46, v62
    v_fmac_f32 v53, v47, v63
    s_cmp_eq_u32 s43, 2
    v_bfi_b32 v52, v9, s19, v52
    v_bfi_b32 v53, v9, s37, v53
    v_bfi_b32 v54, v9, s38, v54
    v_bfi_b32 v55, v9, s39, v55
    s_mov_b32 exec_lo, 15
    s_mov_b32 exec_hi, 15
    s_cbranch_scc0 L_ps_45
    buffer_store_dwordx4 v[52:55], v15, s[20:23], s59 offen
    s_branch L_pe_46
L_ps_45:
    buffer_store_dwordx4 v[52:55], v15, s[20:23], s59 offen sc1
L_pe_46:
    s_mov_b64 exec, -1
    s_cmp_eq_u32 s52, 3
    s_cbranch_scc1 L_done
    s_cmp_eq_u32 s52, 1
    s_cbranch_scc1 L_pub_w
L_w_47:
    ds_read_b32 v10, v3 offset:360
    s_sub_u32 s54, s54, 1
    s_cbranch_scc1 L_end
    s_waitcnt lgkmcnt(0)
    v_cmp_gt_i32 vcc, 44, v10
    s_cbranch_vccnz L_w_47
    buffer_load_dwordx4 v[124:127], v13, s[20:23], s46 offen sc1
    buffer_load_dwordx4 v[128:131], v13, s[20:23], s47 offen sc1
    s_waitcnt vmcnt(0)
    s_branch L_auxchk
L_pub_w:
L_w_48:
    ds_read_b32 v10, v3 offset:360
    s_sub_u32 s54, s54, 1
    s_cbranch_scc1 L_end
    s_waitcnt lgkmcnt(0)
    v_cmp_gt_i32 vcc, 46, v10
    s_cbranch_vccnz L_w_48
L_spoll:
    buffer_load_dwordx4 v[56:59], v7, s[20:23], s46 offen sc1
    s_sub_u32 s54, s54, 64
    s_cbranch_scc1 L_end
    s_waitcnt vmcnt(0)
    v_xor_b32 v10, s19, v56
    v_bitop3_b32 v10, v10, v57, s37 bitop3:0xf6
    v_bitop3_b32 v10, v10, v58, s38 bitop3:0xf6
    v_bitop3_b32 v10, v10, v59, s39 bitop3:0xf6
    v_and_b32 v10, 0xff, v10
    v_cmp_ne_u32 vcc, 0, v10
    s_cbranch_vccnz L_spoll
    v_and_b32 v56, s55, v56
    v_and_b32 v57, s55, v57
    v_lshlrev_b32 v15, 2, v0
    v_max_f32_dpp v10, v56, v56 quad_perm:[1,0,3,2] row_mask:0xf bank_mask:0xf
    v_and_b32 v15, 0x7c, v15
    s_nop 0
    v_max_f32_dpp v10, v10, v10 quad_perm:[2,3,0,1] row_mask:0xf bank_mask:0xf
    v_sub_f32 v56, v56, v10
    v_mul_f32 v56, s56, v56
    v_exp_f32 v56, v56
    s_nop 0
    v_mul_f32 v57, v56, v57
    s_nop 1
    v_add_f32_dpp v57, v57, v57 quad_perm:[1,0,3,2] row_mask:0xf bank_mask:0xf
    s_nop 1
    v_add_f32_dpp v57, v57, v57 quad_perm:[2,3,0,1] row_mask:0xf bank_mask:0xf
    v_rcp_f32 v57, v57
    s_nop 0
    v_mul_f32 v56, v56, v57
    ds_write_b32 v15, v56 offset:0
    ds_write_b32 v3, v9 offset:368
    s_endpgm
L_reduce:
    v_mov_b32 v10, 7
    ds_write_b32 v4, v10 offset:320
    s_lshr_b32 s56, s35, 1
    s_add_u32 s42, s30, s56
    s_cmp_eq_u32 s30, 7
    s_cselect_b32 s57, 4, 2
    s_cmp_ge_u32 s35, s57
    s_cbranch_scc1 L_done
    s_load_dwordx2 s[28:29], s[0:1], 72
    s_mov_b32 s30, 4608
    s_mov_b32 s31, 0x20000
    s_lshl_b32 s57, s56, 8
    v_lshl_add_u32 v5, v0, 2, s57
    s_lshl_b32 s57, s56, 3
    v_mov_b32 v6, s57
    v_lshrrev_b32 v14, 3, v0
    v_lshlrev_b32 v14, 10, v14
    v_and_b32 v15, 7, v0
    v_lshl_add_u32 v14, v15, 4, v14
    s_and_b32 s58, s35, 1
    s_lshl1_add_u32 s56, s42, s58
    s_lshl_b32 s56, s56, 14
    s_lshl_b32 s57, s33, 7
    s_add_u32 s56, s56, s57
    s_add_u32 s56, s56, 655360
    s_add_u32 s57, s56, 8192
    s_mov_b64 s[4:5], -1
    s_mov_b64 s[6:7], -1
    v_and_b32 v15, 3, v0
    v_mul_u32_u24 v15, 1152, v15
    v_bfe_u32 v1, v0, 2, 1
    v_lshl_add_u32 v15, v1, 3, v15
    v_lshrrev_b32 v1, 4, v0
    v_lshl_add_u32 v1, v1, 1, v15
    s_lshl_b32 s47, s42, 3
    s_add_u32 s47, s47, s33
    s_lshl_b32 s47, s47, 4
    v_not_b32 v40, s19
    v_not_b32 v44, s19
L_w_49:
    ds_read_b32 v10, v12 offset:320
    s_sub_u32 s54, s54, 1
    s_cbranch_scc1 L_end
    s_waitcnt lgkmcnt(0)
    v_cmp_gt_i32 vcc, 7, v10
    s_cbranch_vccnz L_w_49
    s_cmp_eq_u32 s58, 0
    s_cbranch_scc1 L_rs
    s_bitcmp1_b32 0x92, s42
    s_cbranch_scc1 L_r2
    s_mov_b64 s[6:7], 0
    v_mov_b32 v60, 0
    v_mov_b32 v61, 0
    v_mov_b32 v62, 0
    v_mov_b32 v63, 0
L_r2:
    s_or_b64 exec, s[4:5], 1
    buffer_load_dwordx4 v[124:127], v14, s[20:23], s56 offen sc1
    s_or_b64 exec, s[6:7], 1
    buffer_load_dwordx4 v[128:131], v14, s[20:23], s57 offen sc1
L_fpf:
    s_or_b64 exec, s[4:5], 1
    buffer_load_dwordx4 v[132:135], v14, s[20:23], s56 offen sc1
    s_or_b64 exec, s[6:7], 1
    buffer_load_dwordx4 v[136:139], v14, s[20:23], s57 offen sc1
    s_sub_u32 s54, s54, 16
    s_cbranch_scc1 L_end
    s_mov_b64 exec, s[4:5]
    s_waitcnt vmcnt(3)
    v_xor_b32 v56, s19, v124
    v_xor_b32 v57, s37, v125
    v_xor_b32 v58, s38, v126
    v_xor_b32 v59, s39, v127
    v_or3_b32 v10, v56, v57, v58
    v_bitop3_b32 v10, v10, v59, v9 bitop3:0xa8
    v_cmp_ne_u32 s[4:5], 0, v10
    s_mov_b64 exec, s[6:7]
    s_waitcnt vmcnt(2)
    v_xor_b32 v60, s19, v128
    v_xor_b32 v61, s37, v129
    v_xor_b32 v62, s38, v130
    v_xor_b32 v63, s39, v131
    v_or3_b32 v11, v60, v61, v62
    v_bitop3_b32 v11, v11, v63, v9 bitop3:0xa8
    v_cmp_ne_u32 s[6:7], 0, v11
    s_mov_b64 exec, -1
    s_or_b64 vcc, s[4:5], s[6:7]
    s_cbranch_scc0 L_fdf
    s_or_b64 exec, s[4:5], 1
    buffer_load_dwordx4 v[124:127], v14, s[20:23], s56 offen sc1
    s_or_b64 exec, s[6:7], 1
    buffer_load_dwordx4 v[128:131], v14, s[20:23], s57 offen sc1
    s_mov_b64 exec, s[4:5]
    s_waitcnt vmcnt(3)
    v_xor_b32 v56, s19, v132
    v_xor_b32 v57, s37, v133
    v_xor_b32 v58, s38, v134
    v_xor_b32 v59, s39, v135
    v_or3_b32 v10, v56, v57, v58
    v_bitop3_b32 v10, v10, v59, v9 bitop3:0xa8
    v_cmp_ne_u32 s[4:5], 0, v10
    s_mov_b64 exec, s[6:7]
    s_waitcnt vmcnt(2)
    v_xor_b32 v60, s19, v136
    v_xor_b32 v61, s37, v137
    v_xor_b32 v62, s38, v138
    v_xor_b32 v63, s39, v139
    v_or3_b32 v11, v60, v61, v62
    v_bitop3_b32 v11, v11, v63, v9 bitop3:0xa8
    v_cmp_ne_u32 s[6:7], 0, v11
    s_mov_b64 exec, -1
    s_or_b64 vcc, s[4:5], s[6:7]
    s_cbranch_scc1 L_fpf
L_fdf:
    v_pk_add_f32 v[58:59], v[58:59], v[62:63]
    v_pk_add_f32 v[56:57], v[56:57], v[60:61]
    s_nop 1
    v_permlane32_swap_b32 v56, v58
    v_permlane32_swap_b32 v57, v59
    v_pk_add_f32 v[56:57], v[56:57], v[58:59]
    s_nop 1
    v_permlane16_swap_b32 v56, v57
    v_add_f32 v56, v56, v57
    s_nop 1
    v_add_f32_dpp v56, v56, v56 row_ror:8 row_mask:0xf bank_mask:0xf
    v_cvt_pk_bf16_f32 v56, 0, v56
    v_mul_f32 v14, 0xbfb8aa3b, v56
    v_exp_f32 v14, v14
    s_nop 0
    v_add_f32 v14, 1.0, v14
    v_rcp_f32 v14, v14
    s_nop 0
    v_mul_f32 v14, v14, v56
    v_cvt_pk_bf16_f32 v14, 0, v14
    ds_write_b32 v5, v14 offset:2048
    ds_write_b32 v6, v9 offset:368
    s_endpgm
L_rs:
    buffer_load_ushort v2, v1, s[24:27], s47 offen
    s_waitcnt vmcnt(0)
    v_lshlrev_b32 v2, 16, v2
    s_or_b64 exec, s[4:5], 1
    buffer_load_dwordx4 v[124:127], v14, s[20:23], s56 offen sc1
    s_or_b64 exec, s[6:7], 1
    buffer_load_dwordx4 v[128:131], v14, s[20:23], s57 offen sc1
L_fps:
    s_or_b64 exec, s[4:5], 1
    buffer_load_dwordx4 v[132:135], v14, s[20:23], s56 offen sc1
    s_or_b64 exec, s[6:7], 1
    buffer_load_dwordx4 v[136:139], v14, s[20:23], s57 offen sc1
    s_mov_b64 exec, -1
    ds_read_b32 v15, v6 offset:368
    ds_read_b32 v7, v5 offset:2048
    s_sub_u32 s54, s54, 16
    s_cbranch_scc1 L_end
    s_waitcnt lgkmcnt(0)
    v_cmp_eq_u32 vcc, 0, v15
    s_mov_b64 exec, s[4:5]
    s_waitcnt vmcnt(3)
    v_xor_b32 v56, s19, v124
    v_xor_b32 v57, s37, v125
    v_xor_b32 v58, s38, v126
    v_xor_b32 v59, s39, v127
    v_or3_b32 v10, v56, v57, v58
    v_bitop3_b32 v10, v10, v59, v9 bitop3:0xa8
    v_cmp_ne_u32 s[4:5], 0, v10
    s_mov_b64 exec, s[6:7]
    s_waitcnt vmcnt(2)
    v_xor_b32 v60, s19, v128
    v_xor_b32 v61, s37, v129
    v_xor_b32 v62, s38, v130
    v_xor_b32 v63, s39, v131
    v_or3_b32 v11, v60, v61, v62
    v_bitop3_b32 v11, v11, v63, v9 bitop3:0xa8
    v_cmp_ne_u32 s[6:7], 0, v11
    s_mov_b64 exec, -1
    s_or_b64 vcc, vcc, s[4:5]
    s_or_b64 vcc, vcc, s[6:7]
    s_cbranch_scc0 L_fds
    s_or_b64 exec, s[4:5], 1
    buffer_load_dwordx4 v[124:127], v14, s[20:23], s56 offen sc1
    s_or_b64 exec, s[6:7], 1
    buffer_load_dwordx4 v[128:131], v14, s[20:23], s57 offen sc1
    s_mov_b64 exec, -1
    ds_read_b32 v15, v6 offset:368
    ds_read_b32 v7, v5 offset:2048
    s_waitcnt lgkmcnt(0)
    v_cmp_eq_u32 vcc, 0, v15
    s_mov_b64 exec, s[4:5]
    s_waitcnt vmcnt(3)
    v_xor_b32 v56, s19, v132
    v_xor_b32 v57, s37, v133
    v_xor_b32 v58, s38, v134
    v_xor_b32 v59, s39, v135
    v_or3_b32 v10, v56, v57, v58
    v_bitop3_b32 v10, v10, v59, v9 bitop3:0xa8
    v_cmp_ne_u32 s[4:5], 0, v10
    s_mov_b64 exec, s[6:7]
    s_waitcnt vmcnt(2)
    v_xor_b32 v60, s19, v136
    v_xor_b32 v61, s37, v137
    v_xor_b32 v62, s38, v138
    v_xor_b32 v63, s39, v139
    v_or3_b32 v11, v60, v61, v62
    v_bitop3_b32 v11, v11, v63, v9 bitop3:0xa8
    v_cmp_ne_u32 s[6:7], 0, v11
    s_mov_b64 exec, -1
    s_or_b64 vcc, vcc, s[4:5]
    s_or_b64 vcc, vcc, s[6:7]
    s_cbranch_scc1 L_fps
L_fds:
    v_pk_add_f32 v[58:59], v[58:59], v[62:63]
    v_pk_add_f32 v[56:57], v[56:57], v[60:61]
    s_nop 1
    v_permlane32_swap_b32 v56, v58
    v_permlane32_swap_b32 v57, v59
    v_pk_add_f32 v[56:57], v[56:57], v[58:59]
    s_nop 1
    v_permlane16_swap_b32 v56, v57
    v_add_f32 v56, v56, v57
    s_nop 1
    v_add_f32_dpp v56, v56, v56 row_ror:8 row_mask:0xf bank_mask:0xf
    v_cvt_pk_bf16_f32 v56, 0, v56
    s_mov_b32 exec_lo, 0x00ff00ff
    s_mov_b32 exec_hi, 0x00ff00ff
    v_mul_f32 v14, v7, v56
    v_cvt_pk_bf16_f32 v14, 0, v14
    v_add_f32 v14, v14, v2
    v_cvt_pk_bf16_f32 v14, v14, v14
    buffer_store_short v14, v1, s[28:31], s47 offen
    s_cmp_lg_u32 s47, 0
    s_cbranch_scc1 L_done
    s_mov_b64 exec, 1
    v_mov_b32 v14, s32
    buffer_store_dword v14, v3, s[20:23], 0 offen
L_done:
L_end:
    s_endpgm
    .if (L_end - L_epf) < 13060
    .fill (13060 - (L_end - L_epf)) / 4, 4, 0xbf810000
    .endif
.section .rodata,"a"
.p2align 6
.amdhsa_kernel recurrent_scan__sliding_block_cached__glu_gated_geglu__decode_kernel
  .amdhsa_next_free_vgpr 160
  .amdhsa_next_free_sgpr 96
  .amdhsa_accum_offset 160
  .amdhsa_group_segment_fixed_size 0
  .amdhsa_kernarg_size 96
  .amdhsa_user_sgpr_count 2
  .amdhsa_user_sgpr_kernarg_segment_ptr 1
  .amdhsa_system_sgpr_workgroup_id_x 1
  .amdhsa_float_denorm_mode_32 3
.end_amdhsa_kernel
.text
```
